```python
import torch

def _softmax(x, axis=-1):
    return torch.softmax(x, dim=axis)
def _gelu(x):
    return torch.nn.functional.gelu(x, approximate="tanh")
def _silu(x):
    return torch.nn.functional.silu(x)
def _sigmoid(x):
    return torch.sigmoid(x)
def _layernorm(x, axis=-1, eps=1e-5):
    m = x.mean(dim=axis, keepdim=True)
    v = x.var(dim=axis, keepdim=True, unbiased=False)
    return (x - m) / torch.sqrt(v + eps)
def _scatter_add(tgt, idx, src, axis=0):
    return tgt.clone().index_add_(axis, idx, src)
def _segment_sum(src, seg, n):
    out = torch.zeros((n,) + src.shape[1:], dtype=src.dtype)
    return out.index_add_(0, seg, src)
def _pad(x, pw):
    flat = tuple(v for pair in reversed(pw) for v in pair)
    return torch.nn.functional.pad(x, flat)

kernel_name = 'gated_mix__ssm_conv_s4__glu_gated_bilinear__prompt'

def setup_inputs():

    _w = (lambda a: (lambda t: t.to(torch.bfloat16) if t.is_floating_point() else t)(torch.as_tensor(a)))
    def _A_setup():
        B, L, D, N = 1, 2048, 512, 128
        A_re = -(lambda _x: torch.exp(torch.as_tensor(_x)))((lambda *s: torch.randn(*s, dtype=torch.bfloat16) * 3.2)(D, N))
        A_im = torch.pi * (lambda *s: torch.randn(*s, dtype=torch.bfloat16) * 0.05)(D, N)
        B_re = (lambda *s: torch.randn(*s, dtype=torch.bfloat16) * 0.1)(D, N)
        B_im = (lambda *s: torch.randn(*s, dtype=torch.bfloat16) * 0.1)(D, N)
        C_re = (lambda *s: torch.randn(*s, dtype=torch.bfloat16) * 0.1)(D, N)
        C_im = (lambda *s: torch.randn(*s, dtype=torch.bfloat16) * 0.1)(D, N)
        log_dt = (lambda *s: torch.randn(*s, dtype=torch.bfloat16) * 0.05)(D) * 0.5 - 4.0
        Dskip = (lambda *s: torch.randn(*s, dtype=torch.bfloat16) * 0.05)(D)
        return {
            "u": _w((lambda *s: torch.randn(*s, dtype=torch.bfloat16) * 0.05)(B, L, D)),
            "A_re": _w(A_re),
            "A_im": _w(A_im),
            "B_re": _w(B_re),
            "B_im": _w(B_im),
            "C_re": _w(C_re),
            "C_im": _w(C_im),
            "log_dt": _w(log_dt),
            "Dskip": _w(Dskip),
        }
    _A_in = _A_setup()

    def _B_setup():
        B, S, D, F = 1, 2048, 512, 1792
        return {
            "x": _w((lambda *s: torch.randn(*s, dtype=torch.bfloat16) * 0.05)(B, S, D)),
            "w_gate": _w((lambda *s: torch.randn(*s, dtype=torch.bfloat16) * 0.8)(D, F) * (D ** -0.5)),
            "w_up": _w((lambda *s: torch.randn(*s, dtype=torch.bfloat16) * 0.8)(D, F) * (D ** -0.5)),
            "w_down": _w((lambda *s: torch.randn(*s, dtype=torch.bfloat16) * 0.8)(F, D) * (F ** -0.5)),
        }
    _B_in = _B_setup()

    return {
        "A_u": _A_in["u"],
        "A_A_re": _A_in["A_re"],
        "A_A_im": _A_in["A_im"],
        "A_B_re": _A_in["B_re"],
        "A_B_im": _A_in["B_im"],
        "A_C_re": _A_in["C_re"],
        "A_C_im": _A_in["C_im"],
        "A_log_dt": _A_in["log_dt"],
        "A_Dskip": _A_in["Dskip"],
        "B_x": _B_in["x"],
        "B_w_gate": _B_in["w_gate"],
        "B_w_up": _B_in["w_up"],
        "B_w_down": _B_in["w_down"],
        "gate_w": _w((lambda *s: torch.randn(*s, dtype=torch.bfloat16) * 0.05)(512) * 16.0),
    }

def reference(A_u, A_A_re, A_A_im, A_B_re, A_B_im, A_C_re, A_C_im, A_log_dt, A_Dskip, B_x, B_w_gate, B_w_up, B_w_down, gate_w):
    def _A_ref(u, A_re, A_im, B_re, B_im, C_re, C_im, log_dt, Dskip):
        Bsz, L, D = u.shape
        dt = torch.exp(log_dt)[:, None]
        A = A_re + 1j * A_im
        Bc = B_re + 1j * B_im
        Cc = C_re + 1j * C_im
        logdA = dt * A
        dB = dt * Bc
        l = (lambda x, dt: x.to(dt))(torch.arange(L), A_re.dtype)
        P = torch.exp(logdA[:, :, None] * l[None, None, :])
        K = torch.einsum("dn,dnl,dn->dl", Cc, P, dB).real
        L2 = 2 * L
        Kp = _pad(K, ((0, 0), (0, L)))
        up = (lambda x, *d: x.permute(*d))(u, 0, 2, 1)
        up = _pad(up, ((0, 0), (0, 0), (0, L)))
        Kf = (lambda x, axes=(-2,-1): torch.fft.rfft2(x.float(), dim=axes))(Kp[:, None, :], axes=(-2, -1))
        Uf = (lambda x, axes=(-2,-1): torch.fft.rfft2(x.float(), dim=axes))(up[:, :, None, :], axes=(-2, -1))
        Yf = Uf * Kf[None, :, :, :]
        y = (lambda x, s, axes=(-2,-1): torch.fft.irfft2(x, s=s, dim=axes).to(torch.bfloat16))(Yf, (1, L2), axes=(-2, -1))[:, :, 0, :L]
        y = (lambda x, *d: x.permute(*d))(y, 0, 2, 1) + u * Dskip[None, None, :]
        return y

    def _B_ref(x, w_gate, w_up, w_down):
        g = torch.einsum("bsd,df->bsf", x, w_gate)
        u = torch.einsum("bsd,df->bsf", x, w_up)
        h = g * u
        return torch.einsum("bsf,fd->bsd", h, w_down)

    x = A_u
    g = _sigmoid((x * gate_w).sum(-1, keepdims=True))
    a = _A_ref(x, A_A_re, A_A_im, A_B_re, A_B_im, A_C_re, A_C_im, A_log_dt, A_Dskip)
    b = _B_ref(x, B_w_gate, B_w_up, B_w_down)
    return g * a + (1 - g) * b
```

```asm
; @launch grid=(256,1,1) block=(512,1,1) lds=163840
.amdgcn_target "amdgcn-amd-amdhsa--gfx950"
.text
.globl gated_mix__ssm_conv_s4__glu_gated_bilinear__prompt_kernel
.p2align 8
.type gated_mix__ssm_conv_s4__glu_gated_bilinear__prompt_kernel,@function
gated_mix__ssm_conv_s4__glu_gated_bilinear__prompt_kernel:
    s_cmp_ge_u32 s2, 256
    s_cbranch_scc1 Lend
    s_load_dwordx16 s[16:31], s[0:1], 0
    s_load_dwordx16 s[32:47], s[0:1], 64
    s_load_dwordx2 s[48:49], s[0:1], 128
    v_lshlrev_b32 v2, 4, v0
    s_getpc_b64 s[60:61]
Lpc1:
    s_and_b32 s61, s61, 0xffff
    s_mov_b32 s62, Ltable_end-Lpc1
    s_mov_b32 s63, 0x20000
    s_bfe_u32 s3, s2, 0x30003
    s_lshl_b32 s3, s3, 13
    buffer_load_dwordx4 v[148:151], v2, s[60:63], s3 offen
    v_lshrrev_b32 v1, 6, v0
    v_mov_b32 v156, 0
    v_mov_b32 v157, 0
    v_mov_b32 v158, 0
    v_mov_b32 v159, 0
    v_readfirstlane_b32 s4, v1
    ds_write_b128 v2, v[156:159]
    v_and_b32 v0, 63, v0
    s_and_b32 s10, s2, 7
    s_lshr_b32 s11, s2, 3
    s_bfe_u32 s3, s10, 0x10001
    s_lshl_b32 s3, s3, 2
    s_lshr_b32 s7, s11, 3
    s_add_u32 s7, s7, s3
    s_and_b32 s6, s11, 7
    s_and_b32 s5, s11, 3
    s_add_u32 s5, s5, s3
    s_cmp_ge_u32 s11, 24
    s_cselect_b32 s7, 3, s7
    s_cselect_b32 s6, s5, s6
    s_lshr_b32 s3, s10, 2
    s_mul_i32 s3, s3, 7
    s_add_u32 s7, s7, s3
    s_and_b32 s3, s10, 1
    s_lshl_b32 s3, s3, 3
    s_add_u32 s6, s6, s3
    s_lshr_b32 s8, s10, 1
    s_lshl_b32 s8, s8, 3
    s_and_b32 s3, s11, 7
    s_add_u32 s8, s8, s3
    s_and_b32 s9, s10, 1
    s_lshl_b32 s9, s9, 2
    s_lshr_b32 s3, s11, 3
    s_add_u32 s9, s9, s3
    s_and_b32 s5, s4, 3
    s_mov_b32 s67, 0
    v_lshrrev_b32 v1, 3, v0
    v_lshrrev_b32 v4, 4, v0
    v_xor_b32 v2, v4, v0
    v_and_b32 v2, 7, v2
    v_lshlrev_b32 v2, 4, v2
    v_lshl_add_u32 v180, v1, 10, v2
    v_xor_b32 v3, 64, v180
    v_add_u32 v181, 7168, v3
    v_add_u32 v182, 14336, v180
    v_add_u32 v183, 21504, v3
    v_lshlrev_b32 v175, 4, v0
    v_and_b32 v2, 0x70, v175
    v_lshl_add_u32 v176, v1, 10, v2
    v_lshlrev_b32 v2, 1, v4
    v_xor_b32 v2, v2, v0
    v_and_b32 v2, 15, v2
    v_lshlrev_b32 v2, 4, v2
    v_xor_b32 v3, 0x80, v2
    v_mul_u32_u24 v4, 3584, v4
    v_add_u32 v184, v4, v2
    v_add_u32 v3, v4, v3
    v_add_u32 v185, 13312, v184
    v_add_u32 v186, 26624, v3
    v_add_u32 v187, 39936, v3
    s_lshl_b32 s3, s2, 9
    s_lshl_b32 s10, s5, 7
    s_add_u32 s3, s3, s10
    v_lshl_add_u32 v177, v0, 1, s3
    s_mul_i32 s89, s2, 3584
    s_mov_b32 s54, 0x200000
    s_mov_b32 s55, 0x20000
    s_mov_b32 s58, 1835008
    s_mov_b32 s59, 0x20000
    s_lshl_b32 s11, s2, 2
    s_waitcnt lgkmcnt(0)
    s_cmp_lt_u32 s4, 4
    s_cbranch_scc0 Lpre_np
    global_load_ushort v32, v177, s[18:19] nt
    global_load_ushort v33, v177, s[20:21] nt
    global_load_ushort v34, v177, s[22:23] nt
    global_load_ushort v35, v177, s[24:25] nt
    global_load_ushort v36, v177, s[26:27] nt
    global_load_ushort v37, v177, s[28:29] nt
    s_load_dword s50, s[30:31], s11
    s_load_dword s51, s[32:33], s11
Lpre_np:
    s_barrier
    s_mov_b32 s0, 0
    s_mov_b32 s52, s16
    s_and_b32 s53, s17, 0xffff
    s_cmp_lt_u32 s4, 4
    s_cbranch_scc1 Lrole_m0
    s_cmp_eq_u32 s4, 4
    s_cbranch_scc1 Lrole_ld
    s_cmp_eq_u32 s4, 5
    s_cbranch_scc1 Lrole_c
    s_cmp_eq_u32 s4, 6
    s_cselect_b32 s56, s36, s38
    s_cselect_b32 s57, s37, s39
    s_and_b32 s57, s57, 0xffff
    buffer_load_dwordx4 v[148:151], v175, s[56:59], s89 offen offset:0
    buffer_load_dwordx4 v[148:151], v175, s[56:59], s89 offen offset:1024
    buffer_load_dwordx4 v[148:151], v175, s[56:59], s89 offen offset:2048
    buffer_load_dwordx4 v[148:151], v175, s[56:59], s89 offen offset:2560
    s_branch Lrole_kg
Lrole_m0:
    s_setprio 3
    s_branch Lrole_M
Lrole_c:
    s_setprio 3
    s_cmp_eq_u32 s2, 0
    s_cbranch_scc0 Lrole_c2
    s_add_u32 s98, s48, 14712832
    s_addc_u32 s99, s49, 0
    s_load_dwordx2 s[100:101], s[98:99], 0
    s_waitcnt lgkmcnt(0)
    s_add_u32 s100, s100, 0x7f4a7c16
    s_addc_u32 s101, s101, 0x9e3779b9
    s_or_b32 s100, s100, 1
    v_mov_b32 v192, s100
    v_mov_b32 v193, s101
    s_mov_b64 exec, 1
    global_store_dwordx2 v156, v[192:193], s[46:47] sc1
    global_store_dwordx2 v156, v[192:193], s[98:99] sc1
    s_mov_b64 exec, -1
Lrole_c2:
    s_lshr_b32 s66, s7, 1
    s_and_b32 s65, s7, 1
    s_lshl_b32 s3, s6, 1
    s_add_u32 s65, s65, s3
    s_sub_u32 s3, s2, 224
    s_cmp_ge_u32 s2, 224
    s_cselect_b32 s66, 7, s66
    s_cselect_b32 s65, s3, s65
    s_lshl_b32 s64, s65, 16
    s_lshl_b32 s3, s66, 7
    s_add_u32 s64, s64, s3
    buffer_load_dwordx4 v[108:111], v176, s[52:55], s64 offen
    s_add_u32 s64, s64, 8192
    buffer_load_dwordx4 v[112:115], v176, s[52:55], s64 offen
    s_add_u32 s64, s64, 8192
    buffer_load_dwordx4 v[116:119], v176, s[52:55], s64 offen
    s_add_u32 s64, s64, 8192
    buffer_load_dwordx4 v[120:123], v176, s[52:55], s64 offen
    s_add_u32 s64, s64, 8192
    buffer_load_dwordx4 v[124:127], v176, s[52:55], s64 offen
    s_add_u32 s64, s64, 8192
    buffer_load_dwordx4 v[128:131], v176, s[52:55], s64 offen
    s_add_u32 s64, s64, 8192
    buffer_load_dwordx4 v[132:135], v176, s[52:55], s64 offen
    s_add_u32 s64, s64, 8192
    buffer_load_dwordx4 v[136:139], v176, s[52:55], s64 offen
    s_branch Lrole_misc
Lrole_ld:
    s_cmp_ge_u32 s2, 224
    s_cbranch_scc1 Lsvc
    s_lshl_b32 s64, s6, 17
    s_mov_b32 s65, 0
    s_mov_b32 s90, 65536
    s_mov_b32 s91, 81920
    s_mov_b32 s92, 49152
Lld_loop:
    s_lshl_b32 s11, s67, 7
    s_add_u32 s11, s11, s64
    s_add_u32 s67, s67, 1
    s_and_b32 s67, s67, 7
    s_add_u32 m0, s90, 0
    s_nop 0
    buffer_load_dwordx4 v180, s[52:55], s11 offen offset:0 lds
    buffer_load_dwordx4 v181, s[52:55], s11 offen offset:1024 lds
    buffer_load_dwordx4 v182, s[52:55], s11 offen offset:2048 lds
    buffer_load_dwordx4 v183, s[52:55], s11 offen offset:3072 lds
    s_add_u32 m0, s90, 4096
    s_add_u32 s11, s11, 32768
    buffer_load_dwordx4 v180, s[52:55], s11 offen offset:0 lds
    buffer_load_dwordx4 v181, s[52:55], s11 offen offset:1024 lds
    buffer_load_dwordx4 v182, s[52:55], s11 offen offset:2048 lds
    buffer_load_dwordx4 v183, s[52:55], s11 offen offset:3072 lds
    s_add_u32 m0, s90, 8192
    s_add_u32 s11, s11, 32768
    buffer_load_dwordx4 v180, s[52:55], s11 offen offset:0 lds
    buffer_load_dwordx4 v181, s[52:55], s11 offen offset:1024 lds
    buffer_load_dwordx4 v182, s[52:55], s11 offen offset:2048 lds
    buffer_load_dwordx4 v183, s[52:55], s11 offen offset:3072 lds
    s_add_u32 m0, s90, 12288
    s_add_u32 s11, s11, 32768
    buffer_load_dwordx4 v180, s[52:55], s11 offen offset:0 lds
    buffer_load_dwordx4 v181, s[52:55], s11 offen offset:1024 lds
    buffer_load_dwordx4 v182, s[52:55], s11 offen offset:2048 lds
    buffer_load_dwordx4 v183, s[52:55], s11 offen offset:3072 lds
    s_setprio 2
    s_mov_b32 s3, s90
    s_mov_b32 s90, s91
    s_mov_b32 s91, s92
    s_mov_b32 s92, s3
    s_add_u32 s65, s65, 1
    s_cmp_eq_u32 s65, 1
    s_cbranch_scc1 Lld_loop
    s_waitcnt vmcnt(16)
    s_barrier
    s_cmp_lt_u32 s65, 8
    s_cbranch_scc1 Lld_loop
    ds_read_b32 v1, v156 offset:6440
    ds_read_b64 v[6:7], v156 offset:6480
    s_waitcnt lgkmcnt(0)
    v_readfirstlane_b32 s100, v6
    v_readfirstlane_b32 s101, v7
    s_mov_b32 s12, s48
    s_and_b32 s13, s49, 0xffff
    s_mov_b32 s14, 268435456
    s_mov_b32 s15, 0x20000
    v_mov_b32 v162, 8
    s_mov_b32 s0, 4
    v_cmp_gt_u32 vcc, 1, v1
    s_cbranch_vccz Lg2_go_ok
    s_waitcnt vmcnt(0)
    s_mov_b64 exec, 1
    ds_write_b32 v156, v162 offset:6512
    s_mov_b64 exec, -1
    s_branch Lg2_common
Lx_duty:
    s_waitcnt vmcnt(10)
    s_mov_b64 exec, 1
    ds_write_b32 v156, v162 offset:6512
    s_mov_b64 exec, -1
    s_branch Lg2_resume
Lrole_kg:
    s_cmp_ge_u32 s2, 224
    s_cbranch_scc1 Lsvc_k
    s_and_b32 s51, s4, 1
    s_lshl_b32 s66, s7, 8
    s_lshl_b32 s88, s51, 14
    s_mul_i32 s3, s67, 229376
    s_add_u32 s3, s3, s66
    s_add_u32 s67, s67, 1
    s_and_b32 s67, s67, 7
    s_add_u32 m0, s88, 98304
    s_nop 0
    buffer_load_dwordx4 v184, s[56:59], s3 offen offset:0 lds
    buffer_load_dwordx4 v185, s[56:59], s3 offen offset:1024 lds
    buffer_load_dwordx4 v186, s[56:59], s3 offen offset:2048 lds
    buffer_load_dwordx4 v187, s[56:59], s3 offen offset:3072 lds
    s_add_u32 m0, s88, 102400
    s_add_u32 s3, s3, 57344
    buffer_load_dwordx4 v184, s[56:59], s3 offen offset:0 lds
    buffer_load_dwordx4 v185, s[56:59], s3 offen offset:1024 lds
    buffer_load_dwordx4 v186, s[56:59], s3 offen offset:2048 lds
    buffer_load_dwordx4 v187, s[56:59], s3 offen offset:3072 lds
    s_add_u32 m0, s88, 106496
    s_add_u32 s3, s3, 57344
    buffer_load_dwordx4 v184, s[56:59], s3 offen offset:0 lds
    buffer_load_dwordx4 v185, s[56:59], s3 offen offset:1024 lds
    buffer_load_dwordx4 v186, s[56:59], s3 offen offset:2048 lds
    buffer_load_dwordx4 v187, s[56:59], s3 offen offset:3072 lds
    s_add_u32 m0, s88, 110592
    s_add_u32 s3, s3, 57344
    buffer_load_dwordx4 v184, s[56:59], s3 offen offset:0 lds
    buffer_load_dwordx4 v185, s[56:59], s3 offen offset:1024 lds
    buffer_load_dwordx4 v186, s[56:59], s3 offen offset:2048 lds
    buffer_load_dwordx4 v187, s[56:59], s3 offen offset:3072 lds
    s_and_b32 s51, s4, 1
    s_mov_b32 s0, 2
    v_mov_b32 v162, 8
    v_lshlrev_b32 v5, 4, v0
    s_getpc_b64 s[60:61]
Lpc0:
    s_add_u32 s60, s60, Ltable-Lpc0
    s_addc_u32 s61, s61, 0
    s_and_b32 s61, s61, 0xffff
    s_mov_b32 s62, 3072
    s_mov_b32 s63, 0x20000
    s_mov_b32 s12, s48
    s_and_b32 s13, s49, 0xffff
    s_mov_b32 s14, 268435456
    s_mov_b32 s15, 0x20000
    s_mul_i32 s3, s51, 18560
    s_add_u32 s3, s3, 17392
    v_sub_u32 v164, s3, v5
    v_and_b32 v1, 31, v0
    v_lshrrev_b32 v3, 5, v0
    v_mul_u32_u24 v2, 4640, v3
    v_lshl_add_u32 v2, v1, 4, v2
    s_add_u32 s3, s3, 3088
    v_add_u32 v165, s3, v2
    v_lshlrev_b32 v163, 5, v1
    s_lshr_b32 s65, s9, 1
    s_lshl_b32 s65, s65, 10
    s_add_u32 s65, s65, 14745600
    s_lshr_b32 s86, s2, 5
    s_lshl_b32 s86, s86, 10
    s_add_u32 s86, s86, 14778368
    s_lshl_b32 s64, s2, 1
    s_add_u32 s64, s64, s51
    s_lshl_b32 s64, s64, 12
    s_add_u32 s64, s64, 8388608
    s_mul_i32 s3, s51, 4224
    s_add_u32 s3, s3, 7936
    v_add_u32 v166, s3, v5
    s_lshl_b32 s3, s51, 2
    v_mov_b32 v167, s3
    s_setprio 2
    s_mul_i32 s3, s67, 229376
    s_add_u32 s3, s3, s66
    s_add_u32 s67, s67, 1
    s_and_b32 s67, s67, 7
    s_add_u32 m0, s88, 131072
    s_nop 0
    buffer_load_dwordx4 v184, s[56:59], s3 offen offset:0 lds
    buffer_load_dwordx4 v185, s[56:59], s3 offen offset:1024 lds
    buffer_load_dwordx4 v186, s[56:59], s3 offen offset:2048 lds
    buffer_load_dwordx4 v187, s[56:59], s3 offen offset:3072 lds
    s_add_u32 m0, s88, 135168
    s_add_u32 s3, s3, 57344
    buffer_load_dwordx4 v184, s[56:59], s3 offen offset:0 lds
    buffer_load_dwordx4 v185, s[56:59], s3 offen offset:1024 lds
    buffer_load_dwordx4 v186, s[56:59], s3 offen offset:2048 lds
    buffer_load_dwordx4 v187, s[56:59], s3 offen offset:3072 lds
    s_add_u32 m0, s88, 139264
    s_add_u32 s3, s3, 57344
    buffer_load_dwordx4 v184, s[56:59], s3 offen offset:0 lds
    buffer_load_dwordx4 v185, s[56:59], s3 offen offset:1024 lds
    buffer_load_dwordx4 v186, s[56:59], s3 offen offset:2048 lds
    buffer_load_dwordx4 v187, s[56:59], s3 offen offset:3072 lds
    s_add_u32 m0, s88, 143360
    s_add_u32 s3, s3, 57344
    buffer_load_dwordx4 v184, s[56:59], s3 offen offset:0 lds
    buffer_load_dwordx4 v185, s[56:59], s3 offen offset:1024 lds
    buffer_load_dwordx4 v186, s[56:59], s3 offen offset:2048 lds
    buffer_load_dwordx4 v187, s[56:59], s3 offen offset:3072 lds
    s_waitcnt vmcnt(16)
    s_barrier
    buffer_load_dwordx4 v[12:15], v5, s[60:63], 0 offen offset:0
    buffer_load_dwordx4 v[16:19], v5, s[60:63], 0 offen offset:1024
    buffer_load_dwordx4 v[20:23], v5, s[60:63], 0 offen offset:2048
    s_mul_i32 s3, s67, 229376
    s_add_u32 s3, s3, s66
    s_add_u32 s67, s67, 1
    s_and_b32 s67, s67, 7
    s_add_u32 m0, s88, 16384
    s_nop 0
    buffer_load_dwordx4 v184, s[56:59], s3 offen offset:0 lds
    buffer_load_dwordx4 v185, s[56:59], s3 offen offset:1024 lds
    buffer_load_dwordx4 v186, s[56:59], s3 offen offset:2048 lds
    buffer_load_dwordx4 v187, s[56:59], s3 offen offset:3072 lds
    s_add_u32 m0, s88, 20480
    s_add_u32 s3, s3, 57344
    buffer_load_dwordx4 v184, s[56:59], s3 offen offset:0 lds
    buffer_load_dwordx4 v185, s[56:59], s3 offen offset:1024 lds
    buffer_load_dwordx4 v186, s[56:59], s3 offen offset:2048 lds
    buffer_load_dwordx4 v187, s[56:59], s3 offen offset:3072 lds
    s_add_u32 m0, s88, 24576
    s_add_u32 s3, s3, 57344
    buffer_load_dwordx4 v184, s[56:59], s3 offen offset:0 lds
    buffer_load_dwordx4 v185, s[56:59], s3 offen offset:1024 lds
    buffer_load_dwordx4 v186, s[56:59], s3 offen offset:2048 lds
    buffer_load_dwordx4 v187, s[56:59], s3 offen offset:3072 lds
    s_add_u32 m0, s88, 28672
    s_add_u32 s3, s3, 57344
    buffer_load_dwordx4 v184, s[56:59], s3 offen offset:0 lds
    buffer_load_dwordx4 v185, s[56:59], s3 offen offset:1024 lds
    buffer_load_dwordx4 v186, s[56:59], s3 offen offset:2048 lds
    buffer_load_dwordx4 v187, s[56:59], s3 offen offset:3072 lds
    s_mul_i32 s3, s51, 3200
    v_add_u32 v1, s3, v5
    ds_read_b128 v[72:75], v1 offset:0
    ds_read_b128 v[84:87], v166 offset:1024
    ds_read_b128 v[76:79], v1 offset:1024
    ds_read_b128 v[88:91], v166 offset:2048
    ds_read_b128 v[80:83], v1 offset:2048
    ds_read_b128 v[92:95], v166 offset:3072
    s_waitcnt lgkmcnt(0)
    v_add_f32 v72, v72, v84
    v_add_f32 v73, v73, v85
    v_add_f32 v74, v74, v86
    v_add_f32 v75, v75, v87
    v_add_f32 v76, v76, v88
    v_add_f32 v77, v77, v89
    v_add_f32 v78, v78, v90
    v_add_f32 v79, v79, v91
    v_add_f32 v80, v80, v92
    v_add_f32 v81, v81, v93
    v_add_f32 v82, v82, v94
    v_add_f32 v83, v83, v95
    ds_write_b128 v1, v[72:75] offset:0
    ds_write_b128 v1, v[76:79] offset:1024
    ds_write_b128 v1, v[80:83] offset:2048
    s_waitcnt vmcnt(16)
    s_barrier
    s_mul_i32 s89, s2, 3584
    s_add_u32 s89, s89, 917504
    buffer_load_dwordx4 v[148:151], v175, s[56:59], s89 offen offset:0
    buffer_load_dwordx4 v[148:151], v175, s[56:59], s89 offen offset:1024
    buffer_load_dwordx4 v[148:151], v175, s[56:59], s89 offen offset:2048
    buffer_load_dwordx4 v[148:151], v175, s[56:59], s89 offen offset:2560
    s_mul_i32 s3, s67, 229376
    s_add_u32 s3, s3, s66
    s_add_u32 s67, s67, 1
    s_and_b32 s67, s67, 7
    s_add_u32 m0, s88, 98304
    s_nop 0
    buffer_load_dwordx4 v184, s[56:59], s3 offen offset:0 lds
    buffer_load_dwordx4 v185, s[56:59], s3 offen offset:1024 lds
    buffer_load_dwordx4 v186, s[56:59], s3 offen offset:2048 lds
    buffer_load_dwordx4 v187, s[56:59], s3 offen offset:3072 lds
    s_add_u32 m0, s88, 102400
    s_add_u32 s3, s3, 57344
    buffer_load_dwordx4 v184, s[56:59], s3 offen offset:0 lds
    buffer_load_dwordx4 v185, s[56:59], s3 offen offset:1024 lds
    buffer_load_dwordx4 v186, s[56:59], s3 offen offset:2048 lds
    buffer_load_dwordx4 v187, s[56:59], s3 offen offset:3072 lds
    s_add_u32 m0, s88, 106496
    s_add_u32 s3, s3, 57344
    buffer_load_dwordx4 v184, s[56:59], s3 offen offset:0 lds
    buffer_load_dwordx4 v185, s[56:59], s3 offen offset:1024 lds
    buffer_load_dwordx4 v186, s[56:59], s3 offen offset:2048 lds
    buffer_load_dwordx4 v187, s[56:59], s3 offen offset:3072 lds
    s_add_u32 m0, s88, 110592
    s_add_u32 s3, s3, 57344
    buffer_load_dwordx4 v184, s[56:59], s3 offen offset:0 lds
    buffer_load_dwordx4 v185, s[56:59], s3 offen offset:1024 lds
    buffer_load_dwordx4 v186, s[56:59], s3 offen offset:2048 lds
    buffer_load_dwordx4 v187, s[56:59], s3 offen offset:3072 lds
    s_mul_i32 s3, s51, 209718400
    v_add_u32 v12, s3, v12
    v_add_u32 v13, s3, v13
    v_add_u32 v14, s3, v14
    v_add_u32 v15, s3, v15
    v_add_u32 v16, s3, v16
    v_add_u32 v17, s3, v17
    v_add_u32 v18, s3, v18
    v_add_u32 v19, s3, v19
    v_add_u32 v20, s3, v20
    v_add_u32 v21, s3, v21
    v_add_u32 v22, s3, v22
    v_add_u32 v23, s3, v23
    v_and_b32 v24, 0xffff, v12
    v_lshrrev_b32 v25, 16, v12
    v_and_b32 v26, 0xffff, v13
    v_lshrrev_b32 v27, 16, v13
    v_and_b32 v28, 0xffff, v14
    v_lshrrev_b32 v29, 16, v14
    v_and_b32 v30, 0xffff, v15
    v_lshrrev_b32 v31, 16, v15
    v_and_b32 v32, 0xffff, v16
    v_lshrrev_b32 v33, 16, v16
    v_and_b32 v34, 0xffff, v17
    v_lshrrev_b32 v35, 16, v17
    v_and_b32 v36, 0xffff, v18
    v_lshrrev_b32 v37, 16, v18
    v_and_b32 v38, 0xffff, v19
    v_lshrrev_b32 v39, 16, v19
    v_and_b32 v40, 0xffff, v20
    v_lshrrev_b32 v41, 16, v20
    v_and_b32 v42, 0xffff, v21
    v_lshrrev_b32 v43, 16, v21
    v_and_b32 v44, 0xffff, v22
    v_lshrrev_b32 v45, 16, v22
    v_and_b32 v46, 0xffff, v23
    v_lshrrev_b32 v47, 16, v23
    ds_read_b32 v48, v24
    ds_read_b32 v49, v25
    ds_read_b32 v50, v26
    ds_read_b32 v51, v27
    ds_read_b32 v52, v28
    ds_read_b32 v53, v29
    ds_read_b32 v54, v30
    ds_read_b32 v55, v31
    ds_read_b32 v56, v32
    ds_read_b32 v57, v33
    ds_read_b32 v58, v34
    ds_read_b32 v59, v35
    ds_read_b32 v60, v36
    ds_read_b32 v61, v37
    ds_read_b32 v62, v38
    ds_read_b32 v63, v39
    ds_read_b32 v64, v40
    ds_read_b32 v65, v41
    ds_read_b32 v66, v42
    ds_read_b32 v67, v43
    ds_read_b32 v68, v44
    ds_read_b32 v69, v45
    ds_read_b32 v70, v46
    ds_read_b32 v71, v47
    s_waitcnt vmcnt(16)
    s_barrier
    s_mul_i32 s3, s67, 229376
    s_add_u32 s3, s3, s66
    s_add_u32 s67, s67, 1
    s_and_b32 s67, s67, 7
    s_add_u32 m0, s88, 131072
    s_nop 0
    buffer_load_dwordx4 v184, s[56:59], s3 offen offset:0 lds
    buffer_load_dwordx4 v185, s[56:59], s3 offen offset:1024 lds
    buffer_load_dwordx4 v186, s[56:59], s3 offen offset:2048 lds
    buffer_load_dwordx4 v187, s[56:59], s3 offen offset:3072 lds
    s_add_u32 m0, s88, 135168
    s_add_u32 s3, s3, 57344
    buffer_load_dwordx4 v184, s[56:59], s3 offen offset:0 lds
    buffer_load_dwordx4 v185, s[56:59], s3 offen offset:1024 lds
    buffer_load_dwordx4 v186, s[56:59], s3 offen offset:2048 lds
    buffer_load_dwordx4 v187, s[56:59], s3 offen offset:3072 lds
    s_add_u32 m0, s88, 139264
    s_add_u32 s3, s3, 57344
    buffer_load_dwordx4 v184, s[56:59], s3 offen offset:0 lds
    buffer_load_dwordx4 v185, s[56:59], s3 offen offset:1024 lds
    buffer_load_dwordx4 v186, s[56:59], s3 offen offset:2048 lds
    buffer_load_dwordx4 v187, s[56:59], s3 offen offset:3072 lds
    s_add_u32 m0, s88, 143360
    s_add_u32 s3, s3, 57344
    buffer_load_dwordx4 v184, s[56:59], s3 offen offset:0 lds
    buffer_load_dwordx4 v185, s[56:59], s3 offen offset:1024 lds
    buffer_load_dwordx4 v186, s[56:59], s3 offen offset:2048 lds
    buffer_load_dwordx4 v187, s[56:59], s3 offen offset:3072 lds
    ds_read_b64 v[10:11], v156 offset:6480
    s_waitcnt lgkmcnt(0)
    v_readfirstlane_b32 s100, v10
    v_readfirstlane_b32 s101, v11
    v_cvt_pk_bf16_f32 v192, v55, v54
    v_cvt_pk_bf16_f32 v193, v53, v52
    v_cvt_pk_bf16_f32 v194, v51, v50
    v_cvt_pk_bf16_f32 v195, v49, v48
    v_cvt_pk_bf16_f32 v196, v56, v55
    v_cvt_pk_bf16_f32 v197, v54, v53
    v_cvt_pk_bf16_f32 v198, v52, v51
    v_cvt_pk_bf16_f32 v199, v50, v49
    v_cvt_pk_bf16_f32 v200, v57, v56
    v_cvt_pk_bf16_f32 v201, v55, v54
    v_cvt_pk_bf16_f32 v202, v53, v52
    v_cvt_pk_bf16_f32 v203, v51, v50
    v_cvt_pk_bf16_f32 v204, v58, v57
    v_cvt_pk_bf16_f32 v205, v56, v55
    v_cvt_pk_bf16_f32 v206, v54, v53
    v_cvt_pk_bf16_f32 v207, v52, v51
    v_cvt_pk_bf16_f32 v208, v62, v62
    v_cvt_pk_bf16_f32 v209, v61, v61
    v_cvt_pk_bf16_f32 v210, v61, v61
    v_cvt_pk_bf16_f32 v211, v60, v59
    v_cvt_pk_bf16_f32 v212, v62, v62
    v_cvt_pk_bf16_f32 v213, v62, v61
    v_cvt_pk_bf16_f32 v214, v61, v61
    v_cvt_pk_bf16_f32 v215, v61, v60
    v_cvt_pk_bf16_f32 v216, v63, v62
    v_cvt_pk_bf16_f32 v217, v62, v62
    v_cvt_pk_bf16_f32 v218, v61, v61
    v_cvt_pk_bf16_f32 v219, v61, v61
    v_cvt_pk_bf16_f32 v220, v63, v63
    v_cvt_pk_bf16_f32 v221, v62, v62
    v_cvt_pk_bf16_f32 v222, v62, v61
    v_cvt_pk_bf16_f32 v223, v61, v61
    s_waitcnt vmcnt(16)
    s_barrier
    s_mul_i32 s3, s67, 229376
    s_add_u32 s3, s3, s66
    s_add_u32 s67, s67, 1
    s_and_b32 s67, s67, 7
    s_add_u32 m0, s88, 16384
    s_nop 0
    buffer_load_dwordx4 v184, s[56:59], s3 offen offset:0 lds
    buffer_load_dwordx4 v185, s[56:59], s3 offen offset:1024 lds
    buffer_load_dwordx4 v186, s[56:59], s3 offen offset:2048 lds
    buffer_load_dwordx4 v187, s[56:59], s3 offen offset:3072 lds
    s_add_u32 m0, s88, 20480
    s_add_u32 s3, s3, 57344
    buffer_load_dwordx4 v184, s[56:59], s3 offen offset:0 lds
    buffer_load_dwordx4 v185, s[56:59], s3 offen offset:1024 lds
    buffer_load_dwordx4 v186, s[56:59], s3 offen offset:2048 lds
    buffer_load_dwordx4 v187, s[56:59], s3 offen offset:3072 lds
    s_add_u32 m0, s88, 24576
    s_add_u32 s3, s3, 57344
    buffer_load_dwordx4 v184, s[56:59], s3 offen offset:0 lds
    buffer_load_dwordx4 v185, s[56:59], s3 offen offset:1024 lds
    buffer_load_dwordx4 v186, s[56:59], s3 offen offset:2048 lds
    buffer_load_dwordx4 v187, s[56:59], s3 offen offset:3072 lds
    s_add_u32 m0, s88, 28672
    s_add_u32 s3, s3, 57344
    buffer_load_dwordx4 v184, s[56:59], s3 offen offset:0 lds
    buffer_load_dwordx4 v185, s[56:59], s3 offen offset:1024 lds
    buffer_load_dwordx4 v186, s[56:59], s3 offen offset:2048 lds
    buffer_load_dwordx4 v187, s[56:59], s3 offen offset:3072 lds
    v_cvt_pk_bf16_f32 v224, v66, v65
    v_cvt_pk_bf16_f32 v225, v65, v65
    v_cvt_pk_bf16_f32 v226, v65, v65
    v_cvt_pk_bf16_f32 v227, v65, v64
    v_cvt_pk_bf16_f32 v228, v67, v66
    v_cvt_pk_bf16_f32 v229, v65, v65
    v_cvt_pk_bf16_f32 v230, v65, v65
    v_cvt_pk_bf16_f32 v231, v65, v65
    v_cvt_pk_bf16_f32 v232, v67, v67
    v_cvt_pk_bf16_f32 v233, v66, v65
    v_cvt_pk_bf16_f32 v234, v65, v65
    v_cvt_pk_bf16_f32 v235, v65, v65
    v_cvt_pk_bf16_f32 v236, v67, v67
    v_cvt_pk_bf16_f32 v237, v67, v66
    v_cvt_pk_bf16_f32 v238, v65, v65
    v_cvt_pk_bf16_f32 v239, v65, v65
    v_cvt_pk_bf16_f32 v240, v70, v69
    v_cvt_pk_bf16_f32 v241, v69, v69
    v_cvt_pk_bf16_f32 v242, v69, v69
    v_cvt_pk_bf16_f32 v243, v69, v68
    v_cvt_pk_bf16_f32 v244, v71, v70
    v_cvt_pk_bf16_f32 v245, v69, v69
    v_cvt_pk_bf16_f32 v246, v69, v69
    v_cvt_pk_bf16_f32 v247, v69, v69
    v_cvt_pk_bf16_f32 v248, v71, v71
    v_cvt_pk_bf16_f32 v249, v70, v69
    v_cvt_pk_bf16_f32 v250, v69, v69
    v_cvt_pk_bf16_f32 v251, v69, v69
    v_cvt_pk_bf16_f32 v252, v71, v71
    v_cvt_pk_bf16_f32 v253, v71, v70
    v_cvt_pk_bf16_f32 v254, v69, v69
    v_cvt_pk_bf16_f32 v255, v69, v69
    s_waitcnt vmcnt(16)
    s_barrier
    s_mul_i32 s3, s67, 229376
    s_add_u32 s3, s3, s66
    s_add_u32 s67, s67, 1
    s_and_b32 s67, s67, 7
    s_add_u32 m0, s88, 98304
    s_nop 0
    buffer_load_dwordx4 v184, s[56:59], s3 offen offset:0 lds
    buffer_load_dwordx4 v185, s[56:59], s3 offen offset:1024 lds
    buffer_load_dwordx4 v186, s[56:59], s3 offen offset:2048 lds
    buffer_load_dwordx4 v187, s[56:59], s3 offen offset:3072 lds
    s_add_u32 m0, s88, 102400
    s_add_u32 s3, s3, 57344
    buffer_load_dwordx4 v184, s[56:59], s3 offen offset:0 lds
    buffer_load_dwordx4 v185, s[56:59], s3 offen offset:1024 lds
    buffer_load_dwordx4 v186, s[56:59], s3 offen offset:2048 lds
    buffer_load_dwordx4 v187, s[56:59], s3 offen offset:3072 lds
    s_add_u32 m0, s88, 106496
    s_add_u32 s3, s3, 57344
    buffer_load_dwordx4 v184, s[56:59], s3 offen offset:0 lds
    buffer_load_dwordx4 v185, s[56:59], s3 offen offset:1024 lds
    buffer_load_dwordx4 v186, s[56:59], s3 offen offset:2048 lds
    buffer_load_dwordx4 v187, s[56:59], s3 offen offset:3072 lds
    s_add_u32 m0, s88, 110592
    s_add_u32 s3, s3, 57344
    buffer_load_dwordx4 v184, s[56:59], s3 offen offset:0 lds
    buffer_load_dwordx4 v185, s[56:59], s3 offen offset:1024 lds
    buffer_load_dwordx4 v186, s[56:59], s3 offen offset:2048 lds
    buffer_load_dwordx4 v187, s[56:59], s3 offen offset:3072 lds
    s_waitcnt vmcnt(16)
    s_barrier
    s_mul_i32 s3, s67, 229376
    s_add_u32 s3, s3, s66
    s_add_u32 s67, s67, 1
    s_and_b32 s67, s67, 7
    s_add_u32 m0, s88, 131072
    s_nop 0
    buffer_load_dwordx4 v184, s[56:59], s3 offen offset:0 lds
    buffer_load_dwordx4 v185, s[56:59], s3 offen offset:1024 lds
    buffer_load_dwordx4 v186, s[56:59], s3 offen offset:2048 lds
    buffer_load_dwordx4 v187, s[56:59], s3 offen offset:3072 lds
    s_add_u32 m0, s88, 135168
    s_add_u32 s3, s3, 57344
    buffer_load_dwordx4 v184, s[56:59], s3 offen offset:0 lds
    buffer_load_dwordx4 v185, s[56:59], s3 offen offset:1024 lds
    buffer_load_dwordx4 v186, s[56:59], s3 offen offset:2048 lds
    buffer_load_dwordx4 v187, s[56:59], s3 offen offset:3072 lds
    s_add_u32 m0, s88, 139264
    s_add_u32 s3, s3, 57344
    buffer_load_dwordx4 v184, s[56:59], s3 offen offset:0 lds
    buffer_load_dwordx4 v185, s[56:59], s3 offen offset:1024 lds
    buffer_load_dwordx4 v186, s[56:59], s3 offen offset:2048 lds
    buffer_load_dwordx4 v187, s[56:59], s3 offen offset:3072 lds
    s_add_u32 m0, s88, 143360
    s_add_u32 s3, s3, 57344
    buffer_load_dwordx4 v184, s[56:59], s3 offen offset:0 lds
    buffer_load_dwordx4 v185, s[56:59], s3 offen offset:1024 lds
    buffer_load_dwordx4 v186, s[56:59], s3 offen offset:2048 lds
    buffer_load_dwordx4 v187, s[56:59], s3 offen offset:3072 lds
    s_waitcnt vmcnt(16)
    s_barrier
    buffer_load_dwordx2 v[190:191], v163, s[12:15], s86 offen sc1
    s_waitcnt vmcnt(1)
    s_mov_b64 exec, 1
    ds_write_b32 v167, v162 offset:6516
    s_mov_b64 exec, -1
    s_branch Lg2_common
Lk_duty:
    s_waitcnt vmcnt(11)
    s_mov_b64 exec, 1
    ds_write_b32 v167, v162 offset:6516
    s_mov_b64 exec, -1
    s_waitcnt vmcnt(10)
    v_cmp_ne_u64 vcc, s[100:101], v[190:191]
    s_nop 1
    s_cmp_eq_u64 vcc, 0
    s_cselect_b32 s1, 1, 0
    s_cbranch_scc0 Lk_nu
    buffer_load_dwordx4 v[168:171], v6, s[12:15], s64 offen offset:0 sc1
    buffer_load_dwordx4 v[172:175], v6, s[12:15], s64 offen offset:1024 sc1
    buffer_load_dwordx4 v[176:179], v6, s[12:15], s64 offen offset:2048 sc1
    buffer_load_dwordx4 v[180:183], v6, s[12:15], s64 offen offset:3072 sc1
Lk_nu:
    s_branch Lg2_resume
Lk_duty2:
    ds_write_b128 v164, v[192:195] offset:3072
    ds_write_b128 v164, v[196:199] offset:7712
    ds_write_b128 v164, v[200:203] offset:12352
    ds_write_b128 v164, v[204:207] offset:16992
    ds_write_b128 v164, v[208:211] offset:2048
    ds_write_b128 v164, v[212:215] offset:6688
    ds_write_b128 v164, v[216:219] offset:11328
    ds_write_b128 v164, v[220:223] offset:15968
    ds_write_b128 v164, v[224:227] offset:1024
    ds_write_b128 v164, v[228:231] offset:5664
    ds_write_b128 v164, v[232:235] offset:10304
    ds_write_b128 v164, v[236:239] offset:14944
    ds_write_b128 v164, v[240:243] offset:0
    ds_write_b128 v164, v[244:247] offset:4640
    ds_write_b128 v164, v[248:251] offset:9280
    ds_write_b128 v164, v[252:255] offset:13920
    ds_write_b128 v165, v[156:159]
    ds_write_b128 v165, v[156:159] offset:9280
    ds_write_b128 v166, v[156:159]
    s_cmp_eq_u32 s1, 1
    s_cbranch_scc1 Lk_u
    s_mov_b32 s10, 0
Lp_f2:
    buffer_load_dwordx2 v[190:191], v163, s[12:15], s86 offen sc1
    s_waitcnt vmcnt(0)
    v_cmp_ne_u64 vcc, s[100:101], v[190:191]
    s_nop 1
    s_cmp_eq_u64 vcc, 0
    s_cbranch_scc1 Lp_f2_ok
    s_add_u32 s10, s10, 1
    s_sleep 16
    s_cmp_lt_u32 s10, 30000
    s_cbranch_scc1 Lp_f2
Lp_f2_ok:
    buffer_load_dwordx4 v[168:171], v6, s[12:15], s64 offen offset:0 sc1
    buffer_load_dwordx4 v[172:175], v6, s[12:15], s64 offen offset:1024 sc1
    buffer_load_dwordx4 v[176:179], v6, s[12:15], s64 offen offset:2048 sc1
    buffer_load_dwordx4 v[180:183], v6, s[12:15], s64 offen offset:3072 sc1
    s_waitcnt vmcnt(0)
Lk_u:
    s_waitcnt vmcnt(8)
    ds_write_b128 v166, v[168:171] offset:128
    ds_write_b128 v166, v[172:175] offset:1152
    ds_write_b128 v166, v[176:179] offset:2176
    ds_write_b128 v166, v[180:183] offset:3200
    s_mov_b64 exec, 1
    ds_write_b32 v167, v162 offset:6432
    s_mov_b64 exec, -1
    s_mov_b32 s0, 0
    s_setpc_b64 s[90:91]
Lrole_misc:
    v_bfe_u32 v1, v0, 2, 2
    v_and_b32 v2, 3, v0
    v_lshlrev_b32 v2, 3, v2
    v_lshl_add_u32 v3, v1, 7, v2
    v_lshrrev_b32 v2, 4, v0
    v_lshl_add_u32 v144, v2, 10, v3
    s_cmp_ge_u32 s2, 224
    s_cselect_b32 s3, 86272, 0
    s_add_u32 s3, s3, 7936
    v_add_u32 v144, s3, v144
    v_add_u32 v145, s3, v175
    v_and_b32 v3, 15, v0
    v_lshlrev_b32 v3, 12, v3
    v_lshl_add_u32 v146, v2, 4, v3
    v_cmp_gt_u32 vcc, 4, v0
    v_mov_b32 v2, 0x7fffffff
    v_lshlrev_b32 v147, 3, v0
    v_cndmask_b32 v147, v2, v147, vcc
    s_lshl_b32 s88, s66, 18
    s_lshl_b32 s3, s65, 7
    s_add_u32 s88, s88, s3
    s_add_u32 s88, s88, 8388608
    s_lshl_b32 s89, s66, 5
    s_add_u32 s89, s89, s65
    s_lshl_b32 s89, s89, 5
    s_add_u32 s89, s89, 14778368
    s_mov_b32 s0, 5
    s_mov_b32 s12, s48
    s_and_b32 s13, s49, 0xffff
    s_mov_b32 s14, 268435456
    s_mov_b32 s15, 0x20000
    buffer_store_dwordx2 v[156:157], v147, s[12:15], s89 offen sc1
    s_cmp_ge_u32 s2, 224
    s_cbranch_scc1 Lsvc
    s_setprio 2
    s_barrier
    global_load_dwordx2 v[192:193], v156, s[46:47] sc1
    s_barrier
    s_waitcnt vmcnt(0)
    s_mov_b32 s10, 0
Lmi_tg:
    v_readfirstlane_b32 s100, v192
    v_readfirstlane_b32 s101, v193
    s_nop 0
    s_bitcmp1_b32 s100, 0
    s_cbranch_scc1 Lmi_tg_ok
    s_sleep 2
    global_load_dwordx2 v[192:193], v156, s[46:47] sc1
    s_waitcnt vmcnt(0)
    s_add_u32 s10, s10, 1
    s_cmp_lt_u32 s10, 30000
    s_cbranch_scc1 Lmi_tg
Lmi_tg_ok:
    s_mov_b64 exec, 1
    ds_write_b64 v156, v[192:193] offset:6480
    s_mov_b64 exec, -1
    s_waitcnt vmcnt(0)
    s_call_b64 s[90:91], Lut_tr
    s_barrier
    s_call_b64 s[90:91], Lut_st
    s_barrier
    s_barrier
    s_waitcnt vmcnt(0)
    buffer_store_dwordx2 v[192:193], v147, s[12:15], s89 offen sc1
    s_barrier
    v_and_b32 v143, 31, v0
    v_lshlrev_b32 v143, 5, v143
    s_lshr_b32 s65, s9, 1
    s_lshl_b32 s65, s65, 10
    s_add_u32 s65, s65, 14745600
    v_mov_b32 v142, 8
    buffer_load_dwordx2 v[140:141], v143, s[12:15], s65 offen sc1
    s_barrier
    s_waitcnt vmcnt(0)
    v_cmp_ne_u64 vcc, s[100:101], v[140:141]
    s_nop 1
    s_cmp_eq_u64 vcc, 0
    s_cbranch_scc1 Lp_fm_ok
Lp_fm_in:
    s_mov_b32 s10, 0
Lp_fm:
    buffer_load_dwordx2 v[140:141], v143, s[12:15], s65 offen sc1
    s_waitcnt vmcnt(0)
    v_cmp_ne_u64 vcc, s[100:101], v[140:141]
    s_nop 1
    s_cmp_eq_u64 vcc, 0
    s_cbranch_scc1 Lp_fm_ok
    s_add_u32 s10, s10, 1
    s_sleep 8
    s_cmp_lt_u32 s10, 30000
    s_cbranch_scc1 Lp_fm
Lp_fm_ok:
    s_mov_b64 exec, 1
    ds_write_b32 v156, v142 offset:6440
    s_mov_b64 exec, -1
    s_branch Lg2_go_ok
    s_branch Lg2_common
Lut_st:
    s_add_u32 s3, s88, 0
    buffer_store_dwordx4 v[108:111], v146, s[12:15], s3 offen offset:0 sc1
    buffer_store_dwordx4 v[124:127], v146, s[12:15], s3 offen offset:64 sc1
    s_add_u32 s3, s88, 65536
    buffer_store_dwordx4 v[112:115], v146, s[12:15], s3 offen offset:0 sc1
    buffer_store_dwordx4 v[128:131], v146, s[12:15], s3 offen offset:64 sc1
    s_add_u32 s3, s88, 131072
    buffer_store_dwordx4 v[116:119], v146, s[12:15], s3 offen offset:0 sc1
    buffer_store_dwordx4 v[132:135], v146, s[12:15], s3 offen offset:64 sc1
    s_add_u32 s3, s88, 196608
    buffer_store_dwordx4 v[120:123], v146, s[12:15], s3 offen offset:0 sc1
    buffer_store_dwordx4 v[136:139], v146, s[12:15], s3 offen offset:64 sc1
    s_setpc_b64 s[90:91]
Lut_tr:
    ds_write_b128 v145, v[108:111] offset:0
    ds_write_b128 v145, v[112:115] offset:1024
    ds_write_b128 v145, v[116:119] offset:2048
    ds_write_b128 v145, v[120:123] offset:3072
    ds_write_b128 v145, v[124:127] offset:4096
    ds_write_b128 v145, v[128:131] offset:5120
    ds_write_b128 v145, v[132:135] offset:6144
    ds_write_b128 v145, v[136:139] offset:7168
    ds_read_b64_tr_b16 v[108:109], v144 offset:0
    ds_read_b64_tr_b16 v[110:111], v144 offset:512
    ds_read_b64_tr_b16 v[112:113], v144 offset:32
    ds_read_b64_tr_b16 v[114:115], v144 offset:544
    ds_read_b64_tr_b16 v[116:117], v144 offset:64
    ds_read_b64_tr_b16 v[118:119], v144 offset:576
    ds_read_b64_tr_b16 v[120:121], v144 offset:96
    ds_read_b64_tr_b16 v[122:123], v144 offset:608
    ds_read_b64_tr_b16 v[124:125], v144 offset:4096
    ds_read_b64_tr_b16 v[126:127], v144 offset:4608
    ds_read_b64_tr_b16 v[128:129], v144 offset:4128
    ds_read_b64_tr_b16 v[130:131], v144 offset:4640
    ds_read_b64_tr_b16 v[132:133], v144 offset:4160
    ds_read_b64_tr_b16 v[134:135], v144 offset:4672
    ds_read_b64_tr_b16 v[136:137], v144 offset:4192
    ds_read_b64_tr_b16 v[138:139], v144 offset:4704
    s_waitcnt lgkmcnt(0)
    s_setpc_b64 s[90:91]
Lsvc_k:
    s_mul_i32 s89, s2, 3584
    s_add_u32 s89, s89, 917504
    buffer_load_dwordx4 v[148:151], v175, s[56:59], s89 offen offset:0
    buffer_load_dwordx4 v[148:151], v175, s[56:59], s89 offen offset:1024
    buffer_load_dwordx4 v[148:151], v175, s[56:59], s89 offen offset:2048
    buffer_load_dwordx4 v[148:151], v175, s[56:59], s89 offen offset:2560
Lsvc:
    s_sub_u32 s66, s2, 224
    s_lshl_b32 s3, s5, 8
    s_min_u32 s64, s66, 27
    s_lshl_b32 s64, s64, 16
    s_add_u32 s64, s64, s3
    s_mov_b32 s56, s40
    s_and_b32 s57, s41, 0xffff
    s_add_u32 s3, s64, 0
    buffer_load_dwordx4 v[12:15], v176, s[56:59], s3 offen offset:0 nt
    s_add_u32 s3, s64, 8192
    buffer_load_dwordx4 v[16:19], v176, s[56:59], s3 offen offset:0 nt
    s_add_u32 s3, s64, 16384
    buffer_load_dwordx4 v[20:23], v176, s[56:59], s3 offen offset:0 nt
    s_add_u32 s3, s64, 24576
    buffer_load_dwordx4 v[24:27], v176, s[56:59], s3 offen offset:0 nt
    s_add_u32 s3, s64, 32768
    buffer_load_dwordx4 v[28:31], v176, s[56:59], s3 offen offset:0 nt
    s_add_u32 s3, s64, 40960
    buffer_load_dwordx4 v[32:35], v176, s[56:59], s3 offen offset:0 nt
    s_add_u32 s3, s64, 49152
    buffer_load_dwordx4 v[36:39], v176, s[56:59], s3 offen offset:0 nt
    s_add_u32 s3, s64, 57344
    buffer_load_dwordx4 v[40:43], v176, s[56:59], s3 offen offset:0 nt
    s_add_u32 s3, s64, 0
    buffer_load_dwordx4 v[44:47], v176, s[56:59], s3 offen offset:128 nt
    s_add_u32 s3, s64, 8192
    buffer_load_dwordx4 v[48:51], v176, s[56:59], s3 offen offset:128 nt
    s_add_u32 s3, s64, 16384
    buffer_load_dwordx4 v[52:55], v176, s[56:59], s3 offen offset:128 nt
    s_add_u32 s3, s64, 24576
    buffer_load_dwordx4 v[56:59], v176, s[56:59], s3 offen offset:128 nt
    s_add_u32 s3, s64, 32768
    buffer_load_dwordx4 v[60:63], v176, s[56:59], s3 offen offset:128 nt
    s_add_u32 s3, s64, 40960
    buffer_load_dwordx4 v[64:67], v176, s[56:59], s3 offen offset:128 nt
    s_add_u32 s3, s64, 49152
    buffer_load_dwordx4 v[68:71], v176, s[56:59], s3 offen offset:128 nt
    s_add_u32 s3, s64, 57344
    buffer_load_dwordx4 v[72:75], v176, s[56:59], s3 offen offset:128 nt
    s_mov_b32 s12, s48
    s_and_b32 s13, s49, 0xffff
    s_mov_b32 s14, 268435456
    s_mov_b32 s15, 0x20000
    s_mul_i32 s10, s5, 20480
    s_add_u32 s10, s10, 65536
    v_add_u32 v5, s10, v175
    v_bfe_u32 v1, v0, 2, 2
    v_and_b32 v2, 3, v0
    v_lshlrev_b32 v2, 3, v2
    v_lshl_add_u32 v3, v1, 7, v2
    v_add_u32 v3, s10, v3
    v_lshrrev_b32 v4, 5, v0
    v_lshl_add_u32 v7, v4, 10, v3
    v_bfe_u32 v4, v0, 4, 1
    v_lshl_add_u32 v7, v4, 5, v7
    s_cmp_ge_u32 s66, 28
    s_cselect_b32 s3, 0x7ff00000, 0
    v_add_u32 v9, s3, v175
    v_cmp_gt_u32 vcc, 4, v0
    v_mov_b32 v2, 0x7fffffff
    v_lshlrev_b32 v160, 3, v0
    v_cndmask_b32 v160, v2, v160, vcc
    s_mul_i32 s60, s5, 458752
    s_lshl_b32 s3, s66, 13
    s_add_u32 s60, s60, s3
    s_add_u32 s60, s60, 12582912
    s_lshl_b32 s62, s5, 5
    s_add_u32 s62, s62, s66
    s_lshl_b32 s62, s62, 5
    s_add_u32 s62, s62, 14745600
    buffer_store_dwordx2 v[156:157], v160, s[12:15], s62 offen sc1
    s_waitcnt vmcnt(8)
    ds_write_b128 v5, v[12:15] offset:0
    ds_write_b128 v5, v[16:19] offset:1024
    ds_write_b128 v5, v[20:23] offset:2048
    ds_write_b128 v5, v[24:27] offset:3072
    ds_write_b128 v5, v[28:31] offset:4096
    ds_write_b128 v5, v[32:35] offset:5120
    ds_write_b128 v5, v[36:39] offset:6144
    ds_write_b128 v5, v[40:43] offset:7168
    ds_read_b64_tr_b16 v[12:13], v7 offset:0
    ds_read_b64_tr_b16 v[14:15], v7 offset:512
    ds_read_b64_tr_b16 v[16:17], v7 offset:64
    ds_read_b64_tr_b16 v[18:19], v7 offset:576
    ds_read_b64_tr_b16 v[20:21], v7 offset:2048
    ds_read_b64_tr_b16 v[22:23], v7 offset:2560
    ds_read_b64_tr_b16 v[24:25], v7 offset:2112
    ds_read_b64_tr_b16 v[26:27], v7 offset:2624
    ds_read_b64_tr_b16 v[28:29], v7 offset:4096
    ds_read_b64_tr_b16 v[30:31], v7 offset:4608
    ds_read_b64_tr_b16 v[32:33], v7 offset:4160
    ds_read_b64_tr_b16 v[34:35], v7 offset:4672
    ds_read_b64_tr_b16 v[36:37], v7 offset:6144
    ds_read_b64_tr_b16 v[38:39], v7 offset:6656
    ds_read_b64_tr_b16 v[40:41], v7 offset:6208
    ds_read_b64_tr_b16 v[42:43], v7 offset:6720
    s_waitcnt lgkmcnt(0)
    s_add_u32 s3, s60, 0
    buffer_store_dwordx4 v[12:15], v9, s[12:15], s3 offen offset:0 sc1
    buffer_store_dwordx4 v[16:19], v9, s[12:15], s3 offen offset:1024 sc1
    buffer_store_dwordx4 v[20:23], v9, s[12:15], s3 offen offset:2048 sc1
    buffer_store_dwordx4 v[24:27], v9, s[12:15], s3 offen offset:3072 sc1
    s_add_u32 s3, s60, 4096
    buffer_store_dwordx4 v[28:31], v9, s[12:15], s3 offen offset:0 sc1
    buffer_store_dwordx4 v[32:35], v9, s[12:15], s3 offen offset:1024 sc1
    buffer_store_dwordx4 v[36:39], v9, s[12:15], s3 offen offset:2048 sc1
    buffer_store_dwordx4 v[40:43], v9, s[12:15], s3 offen offset:3072 sc1
    s_waitcnt vmcnt(8)
    ds_write_b128 v5, v[44:47] offset:0
    ds_write_b128 v5, v[48:51] offset:1024
    ds_write_b128 v5, v[52:55] offset:2048
    ds_write_b128 v5, v[56:59] offset:3072
    ds_write_b128 v5, v[60:63] offset:4096
    ds_write_b128 v5, v[64:67] offset:5120
    ds_write_b128 v5, v[68:71] offset:6144
    ds_write_b128 v5, v[72:75] offset:7168
    ds_read_b64_tr_b16 v[44:45], v7 offset:0
    ds_read_b64_tr_b16 v[46:47], v7 offset:512
    ds_read_b64_tr_b16 v[48:49], v7 offset:64
    ds_read_b64_tr_b16 v[50:51], v7 offset:576
    ds_read_b64_tr_b16 v[52:53], v7 offset:2048
    ds_read_b64_tr_b16 v[54:55], v7 offset:2560
    ds_read_b64_tr_b16 v[56:57], v7 offset:2112
    ds_read_b64_tr_b16 v[58:59], v7 offset:2624
    ds_read_b64_tr_b16 v[60:61], v7 offset:4096
    ds_read_b64_tr_b16 v[62:63], v7 offset:4608
    ds_read_b64_tr_b16 v[64:65], v7 offset:4160
    ds_read_b64_tr_b16 v[66:67], v7 offset:4672
    ds_read_b64_tr_b16 v[68:69], v7 offset:6144
    ds_read_b64_tr_b16 v[70:71], v7 offset:6656
    ds_read_b64_tr_b16 v[72:73], v7 offset:6208
    ds_read_b64_tr_b16 v[74:75], v7 offset:6720
    s_waitcnt lgkmcnt(0)
    s_add_u32 s3, s60, 229376
    buffer_store_dwordx4 v[44:47], v9, s[12:15], s3 offen offset:0 sc1
    buffer_store_dwordx4 v[48:51], v9, s[12:15], s3 offen offset:1024 sc1
    buffer_store_dwordx4 v[52:55], v9, s[12:15], s3 offen offset:2048 sc1
    buffer_store_dwordx4 v[56:59], v9, s[12:15], s3 offen offset:3072 sc1
    s_add_u32 s3, s60, 233472
    buffer_store_dwordx4 v[60:63], v9, s[12:15], s3 offen offset:0 sc1
    buffer_store_dwordx4 v[64:67], v9, s[12:15], s3 offen offset:1024 sc1
    buffer_store_dwordx4 v[68:71], v9, s[12:15], s3 offen offset:2048 sc1
    buffer_store_dwordx4 v[72:75], v9, s[12:15], s3 offen offset:3072 sc1
    s_cmp_eq_u32 s0, 5
    s_cbranch_scc0 Lsvc_nx
    s_call_b64 s[90:91], Lut_tr
    s_call_b64 s[90:91], Lut_st
Lsvc_nx:
    global_load_dwordx2 v[10:11], v156, s[46:47] sc1
    s_waitcnt vmcnt(0)
    s_mov_b32 s10, 0
Lsv_tg:
    v_readfirstlane_b32 s100, v10
    v_readfirstlane_b32 s101, v11
    s_nop 0
    s_bitcmp1_b32 s100, 0
    s_cbranch_scc1 Lsv_tg_ok
    s_sleep 2
    global_load_dwordx2 v[10:11], v156, s[46:47] sc1
    s_waitcnt vmcnt(0)
    s_add_u32 s10, s10, 1
    s_cmp_lt_u32 s10, 30000
    s_cbranch_scc1 Lsv_tg
Lsv_tg_ok:
    buffer_store_dwordx2 v[10:11], v160, s[12:15], s62 offen sc1
    s_cmp_eq_u32 s0, 5
    s_cbranch_scc0 Lsvc_ny
    buffer_store_dwordx2 v[10:11], v160, s[12:15], s89 offen sc1
    s_mov_b64 exec, 1
    ds_write_b64 v156, v[10:11] offset:6480
    s_mov_b64 exec, -1
    s_waitcnt lgkmcnt(0)
Lsvc_ny:
    s_barrier
    s_cmp_ge_u32 s4, 6
    s_cbranch_scc1 Lsvc_k2
    s_branch Lg2_common
Lsvc_k2:
    s_nop 1
    s_and_b32 s51, s4, 1
    s_mov_b32 s0, 2
    v_mov_b32 v162, 8
    v_lshlrev_b32 v5, 4, v0
    s_getpc_b64 s[60:61]
Lpc0s:
    s_add_u32 s60, s60, Ltable-Lpc0s
    s_addc_u32 s61, s61, 0
    s_and_b32 s61, s61, 0xffff
    s_mov_b32 s62, 3072
    s_mov_b32 s63, 0x20000
    s_mov_b32 s12, s48
    s_and_b32 s13, s49, 0xffff
    s_mov_b32 s14, 268435456
    s_mov_b32 s15, 0x20000
    s_mul_i32 s3, s51, 18560
    s_add_u32 s3, s3, 17392
    v_sub_u32 v164, s3, v5
    v_and_b32 v1, 31, v0
    v_lshrrev_b32 v3, 5, v0
    v_mul_u32_u24 v2, 4640, v3
    v_lshl_add_u32 v2, v1, 4, v2
    s_add_u32 s3, s3, 3088
    v_add_u32 v165, s3, v2
    v_lshlrev_b32 v163, 5, v1
    s_lshr_b32 s65, s9, 1
    s_lshl_b32 s65, s65, 10
    s_add_u32 s65, s65, 14745600
    s_lshr_b32 s86, s2, 5
    s_lshl_b32 s86, s86, 10
    s_add_u32 s86, s86, 14778368
    s_lshl_b32 s64, s2, 1
    s_add_u32 s64, s64, s51
    s_lshl_b32 s64, s64, 12
    s_add_u32 s64, s64, 8388608
    s_mul_i32 s3, s51, 4224
    s_add_u32 s3, s3, 7936
    v_add_u32 v166, s3, v5
    s_lshl_b32 s3, s51, 2
    v_mov_b32 v167, s3
    buffer_load_dwordx4 v[12:15], v5, s[60:63], 0 offen offset:0
    buffer_load_dwordx4 v[16:19], v5, s[60:63], 0 offen offset:1024
    buffer_load_dwordx4 v[20:23], v5, s[60:63], 0 offen offset:2048
    s_mul_i32 s3, s51, 3200
    v_add_u32 v1, s3, v5
    ds_read_b128 v[72:75], v1 offset:0
    ds_read_b128 v[84:87], v166 offset:1024
    ds_read_b128 v[76:79], v1 offset:1024
    ds_read_b128 v[88:91], v166 offset:2048
    ds_read_b128 v[80:83], v1 offset:2048
    ds_read_b128 v[92:95], v166 offset:3072
    s_waitcnt lgkmcnt(0)
    v_add_f32 v72, v72, v84
    v_add_f32 v73, v73, v85
    v_add_f32 v74, v74, v86
    v_add_f32 v75, v75, v87
    v_add_f32 v76, v76, v88
    v_add_f32 v77, v77, v89
    v_add_f32 v78, v78, v90
    v_add_f32 v79, v79, v91
    v_add_f32 v80, v80, v92
    v_add_f32 v81, v81, v93
    v_add_f32 v82, v82, v94
    v_add_f32 v83, v83, v95
    ds_write_b128 v1, v[72:75] offset:0
    ds_write_b128 v1, v[76:79] offset:1024
    ds_write_b128 v1, v[80:83] offset:2048
    s_waitcnt vmcnt(0)
    s_mul_i32 s3, s51, 209718400
    v_add_u32 v12, s3, v12
    v_add_u32 v13, s3, v13
    v_add_u32 v14, s3, v14
    v_add_u32 v15, s3, v15
    v_add_u32 v16, s3, v16
    v_add_u32 v17, s3, v17
    v_add_u32 v18, s3, v18
    v_add_u32 v19, s3, v19
    v_add_u32 v20, s3, v20
    v_add_u32 v21, s3, v21
    v_add_u32 v22, s3, v22
    v_add_u32 v23, s3, v23
    v_and_b32 v24, 0xffff, v12
    v_lshrrev_b32 v25, 16, v12
    v_and_b32 v26, 0xffff, v13
    v_lshrrev_b32 v27, 16, v13
    v_and_b32 v28, 0xffff, v14
    v_lshrrev_b32 v29, 16, v14
    v_and_b32 v30, 0xffff, v15
    v_lshrrev_b32 v31, 16, v15
    v_and_b32 v32, 0xffff, v16
    v_lshrrev_b32 v33, 16, v16
    v_and_b32 v34, 0xffff, v17
    v_lshrrev_b32 v35, 16, v17
    v_and_b32 v36, 0xffff, v18
    v_lshrrev_b32 v37, 16, v18
    v_and_b32 v38, 0xffff, v19
    v_lshrrev_b32 v39, 16, v19
    v_and_b32 v40, 0xffff, v20
    v_lshrrev_b32 v41, 16, v20
    v_and_b32 v42, 0xffff, v21
    v_lshrrev_b32 v43, 16, v21
    v_and_b32 v44, 0xffff, v22
    v_lshrrev_b32 v45, 16, v22
    v_and_b32 v46, 0xffff, v23
    v_lshrrev_b32 v47, 16, v23
    ds_read_b32 v48, v24
    ds_read_b32 v49, v25
    ds_read_b32 v50, v26
    ds_read_b32 v51, v27
    ds_read_b32 v52, v28
    ds_read_b32 v53, v29
    ds_read_b32 v54, v30
    ds_read_b32 v55, v31
    ds_read_b32 v56, v32
    ds_read_b32 v57, v33
    ds_read_b32 v58, v34
    ds_read_b32 v59, v35
    ds_read_b32 v60, v36
    ds_read_b32 v61, v37
    ds_read_b32 v62, v38
    ds_read_b32 v63, v39
    ds_read_b32 v64, v40
    ds_read_b32 v65, v41
    ds_read_b32 v66, v42
    ds_read_b32 v67, v43
    ds_read_b32 v68, v44
    ds_read_b32 v69, v45
    ds_read_b32 v70, v46
    ds_read_b32 v71, v47
    s_waitcnt lgkmcnt(0)
    v_cvt_pk_bf16_f32 v192, v55, v54
    v_cvt_pk_bf16_f32 v193, v53, v52
    v_cvt_pk_bf16_f32 v194, v51, v50
    v_cvt_pk_bf16_f32 v195, v49, v48
    v_cvt_pk_bf16_f32 v196, v56, v55
    v_cvt_pk_bf16_f32 v197, v54, v53
    v_cvt_pk_bf16_f32 v198, v52, v51
    v_cvt_pk_bf16_f32 v199, v50, v49
    v_cvt_pk_bf16_f32 v200, v57, v56
    v_cvt_pk_bf16_f32 v201, v55, v54
    v_cvt_pk_bf16_f32 v202, v53, v52
    v_cvt_pk_bf16_f32 v203, v51, v50
    v_cvt_pk_bf16_f32 v204, v58, v57
    v_cvt_pk_bf16_f32 v205, v56, v55
    v_cvt_pk_bf16_f32 v206, v54, v53
    v_cvt_pk_bf16_f32 v207, v52, v51
    v_cvt_pk_bf16_f32 v208, v62, v62
    v_cvt_pk_bf16_f32 v209, v61, v61
    v_cvt_pk_bf16_f32 v210, v61, v61
    v_cvt_pk_bf16_f32 v211, v60, v59
    v_cvt_pk_bf16_f32 v212, v62, v62
    v_cvt_pk_bf16_f32 v213, v62, v61
    v_cvt_pk_bf16_f32 v214, v61, v61
    v_cvt_pk_bf16_f32 v215, v61, v60
    v_cvt_pk_bf16_f32 v216, v63, v62
    v_cvt_pk_bf16_f32 v217, v62, v62
    v_cvt_pk_bf16_f32 v218, v61, v61
    v_cvt_pk_bf16_f32 v219, v61, v61
    v_cvt_pk_bf16_f32 v220, v63, v63
    v_cvt_pk_bf16_f32 v221, v62, v62
    v_cvt_pk_bf16_f32 v222, v62, v61
    v_cvt_pk_bf16_f32 v223, v61, v61
    v_cvt_pk_bf16_f32 v224, v66, v65
    v_cvt_pk_bf16_f32 v225, v65, v65
    v_cvt_pk_bf16_f32 v226, v65, v65
    v_cvt_pk_bf16_f32 v227, v65, v64
    v_cvt_pk_bf16_f32 v228, v67, v66
    v_cvt_pk_bf16_f32 v229, v65, v65
    v_cvt_pk_bf16_f32 v230, v65, v65
    v_cvt_pk_bf16_f32 v231, v65, v65
    v_cvt_pk_bf16_f32 v232, v67, v67
    v_cvt_pk_bf16_f32 v233, v66, v65
    v_cvt_pk_bf16_f32 v234, v65, v65
    v_cvt_pk_bf16_f32 v235, v65, v65
    v_cvt_pk_bf16_f32 v236, v67, v67
    v_cvt_pk_bf16_f32 v237, v67, v66
    v_cvt_pk_bf16_f32 v238, v65, v65
    v_cvt_pk_bf16_f32 v239, v65, v65
    v_cvt_pk_bf16_f32 v240, v70, v69
    v_cvt_pk_bf16_f32 v241, v69, v69
    v_cvt_pk_bf16_f32 v242, v69, v69
    v_cvt_pk_bf16_f32 v243, v69, v68
    v_cvt_pk_bf16_f32 v244, v71, v70
    v_cvt_pk_bf16_f32 v245, v69, v69
    v_cvt_pk_bf16_f32 v246, v69, v69
    v_cvt_pk_bf16_f32 v247, v69, v69
    v_cvt_pk_bf16_f32 v248, v71, v71
    v_cvt_pk_bf16_f32 v249, v70, v69
    v_cvt_pk_bf16_f32 v250, v69, v69
    v_cvt_pk_bf16_f32 v251, v69, v69
    v_cvt_pk_bf16_f32 v252, v71, v71
    v_cvt_pk_bf16_f32 v253, v71, v70
    v_cvt_pk_bf16_f32 v254, v69, v69
    v_cvt_pk_bf16_f32 v255, v69, v69
    s_mov_b32 s10, 0
Lp_f1:
    buffer_load_dwordx2 v[10:11], v163, s[12:15], s65 offen sc1
    s_waitcnt vmcnt(0)
    v_cmp_ne_u64 vcc, s[100:101], v[10:11]
    s_nop 1
    s_cmp_eq_u64 vcc, 0
    s_cbranch_scc1 Lp_f1_ok
    s_add_u32 s10, s10, 1
    s_sleep 8
    s_cmp_lt_u32 s10, 30000
    s_cbranch_scc1 Lp_f1
Lp_f1_ok:
    s_mov_b64 exec, 1
    ds_write_b32 v156, v162 offset:6440
    s_mov_b64 exec, -1
    buffer_load_dwordx2 v[190:191], v163, s[12:15], s86 offen sc1
    s_branch Lg2_go_ok
Lg2_common:
    s_mov_b32 s10, 0
Lg2_go:
    ds_read_b32 v10, v156 offset:6440
    s_waitcnt lgkmcnt(0)
    v_cmp_gt_u32 vcc, 1, v10
    s_cbranch_vccz Lg2_go_ok
    s_sleep 1
    s_add_u32 s10, s10, 1
    s_cmp_lt_u32 s10, 300000
    s_cbranch_scc1 Lg2_go
Lg2_go_ok:
    s_and_b32 s50, s5, 1
    s_lshl_b32 s50, s50, 10
    s_lshr_b32 s51, s5, 1
    s_lshl_b32 s51, s51, 10
    v_lshlrev_b32 v6, 4, v0
    v_add_u32 v1, s50, v6
    v_xor_b32 v2, 0x400, v1
    v_add_u32 v3, s51, v6
    v_xor_b32 v4, 0x400, v3
    s_mul_i32 s3, s5, 57344
    s_mul_i32 s60, s9, 229376
    s_add_u32 s60, s60, s3
    s_add_u32 s60, s60, 12582912
    s_mul_i32 s61, s8, 229376
    s_add_u32 s61, s61, s3
    s_mov_b32 s34, 0
    v_min_u32 v9, 3, v0
    v_lshlrev_b32 v9, 2, v9
    s_add_u32 s62, s60, 0
    buffer_load_dwordx4 v[12:15], v1, s[12:15], s62 offen offset:0 sc1
    buffer_load_dwordx4 v[16:19], v2, s[12:15], s62 offen offset:0 sc1
    buffer_load_dwordx4 v[20:23], v1, s[12:15], s62 offen offset:2048 sc1
    buffer_load_dwordx4 v[24:27], v2, s[12:15], s62 offen offset:2048 sc1
    s_add_u32 s62, s60, 4096
    buffer_load_dwordx4 v[28:31], v1, s[12:15], s62 offen offset:0 sc1
    buffer_load_dwordx4 v[32:35], v2, s[12:15], s62 offen offset:0 sc1
    buffer_load_dwordx4 v[36:39], v1, s[12:15], s62 offen offset:2048 sc1
    buffer_load_dwordx4 v[40:43], v2, s[12:15], s62 offen offset:2048 sc1
    s_add_u32 s62, s60, 8192
    buffer_load_dwordx4 v[44:47], v1, s[12:15], s62 offen offset:0 sc1
    buffer_load_dwordx4 v[48:51], v2, s[12:15], s62 offen offset:0 sc1
    s_cmp_eq_u32 s0, 2
    s_cbranch_scc1 Lk_duty
    s_cmp_eq_u32 s0, 4
    s_cbranch_scc1 Lx_duty
Lg2_resume:
    s_add_u32 s62, s60, 8192
    buffer_load_dwordx4 v[52:55], v1, s[12:15], s62 offen offset:2048 sc1
    buffer_load_dwordx4 v[56:59], v2, s[12:15], s62 offen offset:2048 sc1
    s_add_u32 s62, s60, 12288
    buffer_load_dwordx4 v[60:63], v1, s[12:15], s62 offen offset:0 sc1
    buffer_load_dwordx4 v[64:67], v2, s[12:15], s62 offen offset:0 sc1
    buffer_load_dwordx4 v[68:71], v1, s[12:15], s62 offen offset:2048 sc1
    buffer_load_dwordx4 v[72:75], v2, s[12:15], s62 offen offset:2048 sc1
    s_add_u32 s62, s60, 16384
    buffer_load_dwordx4 v[76:79], v1, s[12:15], s62 offen offset:0 sc1
    buffer_load_dwordx4 v[80:83], v2, s[12:15], s62 offen offset:0 sc1
    s_cmp_ge_u32 s2, 224
    s_cbranch_scc0 Lg2_resume2
    s_cmp_eq_u32 s0, 2
    s_cbranch_scc0 Lg2_resume2
    s_call_b64 s[90:91], Lk_duty2
Lg2_resume2:
    s_setprio 0
    s_mov_b32 s10, 0
Lg_ps0:
    ds_read_b32 v10, v9 offset:6464
    s_waitcnt lgkmcnt(0)
    v_cmp_ne_u32 vcc, 0, v10
    s_cbranch_vccz Lg_ps0_ok
    s_cmp_eq_u32 s0, 2
    s_cbranch_scc0 Lg_ps0_n
    s_call_b64 s[90:91], Lk_duty2
Lg_ps0_n:
    v_cmp_eq_u32 vcc, 1, v10
    s_cbranch_vccz Lg_ps0_ok
    s_sleep 1
    s_add_u32 s10, s10, 1
    s_cmp_lt_u32 s10, 300000
    s_cbranch_scc1 Lg_ps0
Lg_ps0_ok:
    s_add_u32 s62, s60, 16384
    buffer_load_dwordx4 v[84:87], v1, s[12:15], s62 offen offset:2048 sc1
    buffer_load_dwordx4 v[88:91], v2, s[12:15], s62 offen offset:2048 sc1
    s_add_u32 s62, s60, 20480
    buffer_load_dwordx4 v[92:95], v1, s[12:15], s62 offen offset:0 sc1
    buffer_load_dwordx4 v[96:99], v2, s[12:15], s62 offen offset:0 sc1
    s_mov_b32 s10, 0
Lg_ps1:
    ds_read_b32 v10, v9 offset:6464
    s_waitcnt lgkmcnt(0)
    v_cmp_ne_u32 vcc, 0, v10
    s_cbranch_vccz Lg_ps1_ok
    s_cmp_eq_u32 s0, 2
    s_cbranch_scc0 Lg_ps1_n
    s_call_b64 s[90:91], Lk_duty2
Lg_ps1_n:
    v_cmp_eq_u32 vcc, 1, v10
    s_cbranch_vccz Lg_ps1_ok
    s_sleep 1
    s_add_u32 s10, s10, 1
    s_cmp_lt_u32 s10, 300000
    s_cbranch_scc1 Lg_ps1
Lg_ps1_ok:
    s_add_u32 s62, s60, 20480
    buffer_load_dwordx4 v[100:103], v1, s[12:15], s62 offen offset:2048 sc1
    buffer_load_dwordx4 v[104:107], v2, s[12:15], s62 offen offset:2048 sc1
    s_add_u32 s62, s60, 24576
    buffer_load_dwordx4 v[108:111], v1, s[12:15], s62 offen offset:0 sc1
    buffer_load_dwordx4 v[112:115], v2, s[12:15], s62 offen offset:0 sc1
    s_mov_b32 s10, 0
Lg_ps2:
    ds_read_b32 v10, v9 offset:6464
    s_waitcnt lgkmcnt(0)
    v_cmp_ne_u32 vcc, 0, v10
    s_cbranch_vccz Lg_ps2_ok
    s_cmp_eq_u32 s0, 2
    s_cbranch_scc0 Lg_ps2_n
    s_call_b64 s[90:91], Lk_duty2
Lg_ps2_n:
    v_cmp_eq_u32 vcc, 1, v10
    s_cbranch_vccz Lg_ps2_ok
    s_sleep 1
    s_add_u32 s10, s10, 1
    s_cmp_lt_u32 s10, 300000
    s_cbranch_scc1 Lg_ps2
Lg_ps2_ok:
    s_add_u32 s62, s60, 24576
    buffer_load_dwordx4 v[116:119], v1, s[12:15], s62 offen offset:2048 sc1
    buffer_load_dwordx4 v[120:123], v2, s[12:15], s62 offen offset:2048 sc1
    s_add_u32 s62, s60, 28672
    buffer_load_dwordx4 v[124:127], v1, s[12:15], s62 offen offset:0 sc1
    buffer_load_dwordx4 v[128:131], v2, s[12:15], s62 offen offset:0 sc1
    s_mov_b32 s10, 0
Lg_ps3:
    ds_read_b32 v10, v9 offset:6464
    s_waitcnt lgkmcnt(0)
    v_cmp_ne_u32 vcc, 0, v10
    s_cbranch_vccz Lg_ps3_ok
    s_cmp_eq_u32 s0, 2
    s_cbranch_scc0 Lg_ps3_n
    s_call_b64 s[90:91], Lk_duty2
Lg_ps3_n:
    v_cmp_eq_u32 vcc, 1, v10
    s_cbranch_vccz Lg_ps3_ok
    s_sleep 1
    s_add_u32 s10, s10, 1
    s_cmp_lt_u32 s10, 300000
    s_cbranch_scc1 Lg_ps3
Lg_ps3_ok:
    s_add_u32 s62, s60, 28672
    buffer_load_dwordx4 v[132:135], v1, s[12:15], s62 offen offset:2048 sc1
    buffer_load_dwordx4 v[136:139], v2, s[12:15], s62 offen offset:2048 sc1
    s_add_u32 s62, s60, 32768
    buffer_load_dwordx4 v[140:143], v1, s[12:15], s62 offen offset:0 sc1
    buffer_load_dwordx4 v[144:147], v2, s[12:15], s62 offen offset:0 sc1
    s_mov_b32 s10, 0
Lg_ps4:
    ds_read_b32 v10, v9 offset:6464
    s_waitcnt lgkmcnt(0)
    v_cmp_ne_u32 vcc, 0, v10
    s_cbranch_vccz Lg_ps4_ok
    s_cmp_eq_u32 s0, 2
    s_cbranch_scc0 Lg_ps4_n
    s_call_b64 s[90:91], Lk_duty2
Lg_ps4_n:
    v_cmp_eq_u32 vcc, 1, v10
    s_cbranch_vccz Lg_ps4_ok
    s_sleep 1
    s_add_u32 s10, s10, 1
    s_cmp_lt_u32 s10, 300000
    s_cbranch_scc1 Lg_ps4
Lg_ps4_ok:
    s_add_u32 s62, s60, 32768
    buffer_load_dwordx4 v[148:151], v1, s[12:15], s62 offen offset:2048 sc1
    buffer_load_dwordx4 v[152:155], v2, s[12:15], s62 offen offset:2048 sc1
    s_cmp_eq_u32 s0, 2
    s_cbranch_scc0 Lg_nd
    s_call_b64 s[90:91], Lk_duty2
Lg_nd:
    s_mul_i32 s52, s5, 20480
    s_add_u32 s52, s52, 65536
    s_add_u32 s53, s52, 12288
    s_mov_b32 s10, 0
Lg_fr:
    ds_read_b32 v10, v9 offset:6400
    s_waitcnt lgkmcnt(0)
    v_cmp_gt_u32 vcc, 8, v10
    s_cbranch_vccz Lg_fr_ok
    s_sleep 1
    s_add_u32 s10, s10, 1
    s_cmp_lt_u32 s10, 300000
    s_cbranch_scc1 Lg_fr
Lg_fr_ok:
    v_min_u32 v5, 6, v0
    v_lshlrev_b32 v5, 7, v5
    s_lshl_b32 s66, s8, 5
    s_mul_i32 s3, s5, 7
    s_add_u32 s66, s66, s3
    s_lshl_b32 s66, s66, 7
    s_add_u32 s66, s66, 14942208
    v_add_u32 v1, s52, v1
    v_add_u32 v2, s52, v2
    v_mov_b32 v11, v6
    s_mov_b32 s10, 0
Lg_ps100:
    ds_read_b32 v10, v9 offset:6464
    s_waitcnt lgkmcnt(0)
    v_cmp_eq_u32 vcc, 1, v10
    s_cbranch_vccz Lg_ps100_ok
    s_sleep 1
    s_add_u32 s10, s10, 1
    s_cmp_lt_u32 s10, 300000
    s_cbranch_scc1 Lg_ps100
Lg_ps100_ok:
    s_add_u32 s62, s60, 36864
    s_add_u32 m0, s52, 0
    s_nop 0
    buffer_load_dwordx4 v11, s[12:15], s62 offen offset:0 sc1 lds
    buffer_load_dwordx4 v11, s[12:15], s62 offen offset:1024 sc1 lds
    buffer_load_dwordx4 v11, s[12:15], s62 offen offset:2048 sc1 lds
    buffer_load_dwordx4 v11, s[12:15], s62 offen offset:3072 sc1 lds
    s_mov_b32 s10, 0
Lg_ps101:
    ds_read_b32 v10, v9 offset:6464
    s_waitcnt lgkmcnt(0)
    v_cmp_eq_u32 vcc, 1, v10
    s_cbranch_vccz Lg_ps101_ok
    s_sleep 1
    s_add_u32 s10, s10, 1
    s_cmp_lt_u32 s10, 300000
    s_cbranch_scc1 Lg_ps101
Lg_ps101_ok:
    s_add_u32 s62, s60, 40960
    s_add_u32 m0, s52, 4096
    s_nop 0
    buffer_load_dwordx4 v11, s[12:15], s62 offen offset:0 sc1 lds
    buffer_load_dwordx4 v11, s[12:15], s62 offen offset:1024 sc1 lds
    buffer_load_dwordx4 v11, s[12:15], s62 offen offset:2048 sc1 lds
    buffer_load_dwordx4 v11, s[12:15], s62 offen offset:3072 sc1 lds
    s_mov_b32 s10, 0
Lg_ps102:
    ds_read_b32 v10, v9 offset:6464
    s_waitcnt lgkmcnt(0)
    v_cmp_eq_u32 vcc, 1, v10
    s_cbranch_vccz Lg_ps102_ok
    s_sleep 1
    s_add_u32 s10, s10, 1
    s_cmp_lt_u32 s10, 300000
    s_cbranch_scc1 Lg_ps102
Lg_ps102_ok:
    buffer_load_dwordx2 v[188:189], v5, s[12:15], s66 offen sc1
    s_add_u32 s62, s60, 45056
    s_add_u32 m0, s52, 8192
    s_nop 0
    buffer_load_dwordx4 v11, s[12:15], s62 offen offset:0 sc1 lds
    buffer_load_dwordx4 v11, s[12:15], s62 offen offset:1024 sc1 lds
    buffer_load_dwordx4 v11, s[12:15], s62 offen offset:2048 sc1 lds
    buffer_load_dwordx4 v11, s[12:15], s62 offen offset:3072 sc1 lds
    s_mov_b32 s10, 0
Lg_ps103:
    ds_read_b32 v10, v9 offset:6464
    s_waitcnt lgkmcnt(0)
    v_cmp_eq_u32 vcc, 1, v10
    s_cbranch_vccz Lg_ps103_ok
    s_sleep 1
    s_add_u32 s10, s10, 1
    s_cmp_lt_u32 s10, 300000
    s_cbranch_scc1 Lg_ps103
Lg_ps103_ok:
    s_add_u32 s62, s60, 49152
    s_add_u32 m0, s52, 12288
    s_nop 0
    buffer_load_dwordx4 v11, s[12:15], s62 offen offset:0 sc1 lds
    buffer_load_dwordx4 v11, s[12:15], s62 offen offset:1024 sc1 lds
    buffer_load_dwordx4 v11, s[12:15], s62 offen offset:2048 sc1 lds
    buffer_load_dwordx4 v11, s[12:15], s62 offen offset:3072 sc1 lds
    s_mov_b32 s10, 0
Lg_ps104:
    ds_read_b32 v10, v9 offset:6464
    s_waitcnt lgkmcnt(0)
    v_cmp_eq_u32 vcc, 1, v10
    s_cbranch_vccz Lg_ps104_ok
    s_sleep 1
    s_add_u32 s10, s10, 1
    s_cmp_lt_u32 s10, 300000
    s_cbranch_scc1 Lg_ps104
Lg_ps104_ok:
    s_add_u32 s62, s60, 53248
    s_add_u32 m0, s52, 16384
    s_nop 0
    buffer_load_dwordx4 v11, s[12:15], s62 offen offset:0 sc1 lds
    buffer_load_dwordx4 v11, s[12:15], s62 offen offset:1024 sc1 lds
    buffer_load_dwordx4 v11, s[12:15], s62 offen offset:2048 sc1 lds
    buffer_load_dwordx4 v11, s[12:15], s62 offen offset:3072 sc1 lds
    s_waitcnt vmcnt(12)
    v_cmp_ne_u64 vcc, s[100:101], v[188:189]
    s_nop 1
    s_cmp_eq_u64 vcc, 0
    s_cbranch_scc1 Lp_h_ok
    s_mov_b32 s10, 0
Lp_h:
    buffer_load_dwordx2 v[188:189], v5, s[12:15], s66 offen sc1
    s_waitcnt vmcnt(0)
    v_cmp_ne_u64 vcc, s[100:101], v[188:189]
    s_nop 1
    s_cmp_eq_u64 vcc, 0
    s_cbranch_scc1 Lp_h_ok
    s_add_u32 s10, s10, 1
    s_sleep 2
    s_cmp_lt_u32 s10, 30000
    s_cbranch_scc1 Lp_h
Lp_h_ok:
    s_setprio 2
    s_add_u32 s63, s61, 0
    buffer_load_dwordx4 v[156:159], v3, s[12:15], s63 offen offset:0 sc1
    buffer_load_dwordx4 v[160:163], v4, s[12:15], s63 offen offset:0 sc1
    buffer_load_dwordx4 v[164:167], v3, s[12:15], s63 offen offset:2048 sc1
    buffer_load_dwordx4 v[168:171], v4, s[12:15], s63 offen offset:2048 sc1
    s_add_u32 s63, s61, 4096
    buffer_load_dwordx4 v[172:175], v3, s[12:15], s63 offen offset:0 sc1
    buffer_load_dwordx4 v[176:179], v4, s[12:15], s63 offen offset:0 sc1
    buffer_load_dwordx4 v[180:183], v3, s[12:15], s63 offen offset:2048 sc1
    buffer_load_dwordx4 v[184:187], v4, s[12:15], s63 offen offset:2048 sc1
    s_add_u32 s63, s61, 8192
    buffer_load_dwordx4 v[188:191], v3, s[12:15], s63 offen offset:0 sc1
    s_lshl_b32 s64, s8, 6
    s_lshr_b32 s3, s51, 5
    s_add_u32 s64, s64, s3
    s_lshl_b32 s65, s9, 6
    s_lshr_b32 s3, s50, 5
    s_add_u32 s65, s65, s3
    s_lshl_b32 s67, s9, 1
    s_lshr_b32 s3, s8, 4
    s_add_u32 s67, s67, s3
    s_lshl_b32 s67, s67, 10
    s_lshr_b32 s3, s50, 5
    s_lshl_b32 s3, s3, 4
    s_add_u32 s67, s67, s3
    s_add_u32 s67, s67, 262144
    v_lshlrev_b32 v5, 4, v0
    v_add_u32 v5, s67, v5
    v_and_b32 v10, 1, v0
    v_lshlrev_b32 v10, 7, v10
    s_lshl_b32 s3, s64, 3
    v_add_u32 v10, s3, v10
    v_cmp_gt_u32 vcc, 32, v0
    s_mov_b32 s67, 14811136
    s_nop 0
    v_cndmask_b32 v5, v10, v5, vcc
    s_waitcnt vmcnt(7)
    v_mfma_f32_32x32x16_bf16 v[240:255], v[16:19], v[160:163], 0
    v_mfma_f32_32x32x16_bf16 v[224:239], v[12:15], v[160:163], 0
    buffer_load_dwordx4 v[160:163], v4, s[12:15], s63 offen offset:0 sc1
    v_mfma_f32_32x32x16_bf16 v[208:223], v[16:19], v[156:159], 0
    buffer_load_dwordx4 v[16:19], v3, s[12:15], s63 offen offset:2048 sc1
    v_mfma_f32_32x32x16_bf16 v[192:207], v[12:15], v[156:159], 0
    buffer_load_dwordx4 v[12:15], v4, s[12:15], s63 offen offset:2048 sc1
    s_add_u32 s63, s61, 12288
    buffer_load_dwordx4 v[156:159], v3, s[12:15], s63 offen offset:0 sc1
    s_waitcnt vmcnt(9)
    v_mfma_f32_32x32x16_bf16 v[240:255], v[24:27], v[168:171], v[240:255]
    v_mfma_f32_32x32x16_bf16 v[224:239], v[20:23], v[168:171], v[224:239]
    buffer_load_dwordx4 v[168:171], v4, s[12:15], s63 offen offset:0 sc1
    v_mfma_f32_32x32x16_bf16 v[208:223], v[24:27], v[164:167], v[208:223]
    buffer_load_dwordx4 v[24:27], v3, s[12:15], s63 offen offset:2048 sc1
    v_mfma_f32_32x32x16_bf16 v[192:207], v[20:23], v[164:167], v[192:207]
    buffer_load_dwordx4 v[20:23], v4, s[12:15], s63 offen offset:2048 sc1
    s_add_u32 s63, s61, 16384
    buffer_load_dwordx4 v[164:167], v3, s[12:15], s63 offen offset:0 sc1
    s_waitcnt vmcnt(11)
    v_mfma_f32_32x32x16_bf16 v[240:255], v[32:35], v[176:179], v[240:255]
    v_mfma_f32_32x32x16_bf16 v[224:239], v[28:31], v[176:179], v[224:239]
    buffer_load_dwordx4 v[176:179], v4, s[12:15], s63 offen offset:0 sc1
    v_mfma_f32_32x32x16_bf16 v[208:223], v[32:35], v[172:175], v[208:223]
    buffer_load_dwordx4 v[32:35], v3, s[12:15], s63 offen offset:2048 sc1
    v_mfma_f32_32x32x16_bf16 v[192:207], v[28:31], v[172:175], v[192:207]
    buffer_load_dwordx4 v[28:31], v4, s[12:15], s63 offen offset:2048 sc1
    s_add_u32 s63, s61, 20480
    buffer_load_dwordx4 v[172:175], v3, s[12:15], s63 offen offset:0 sc1
    s_waitcnt vmcnt(13)
    v_mfma_f32_32x32x16_bf16 v[240:255], v[40:43], v[184:187], v[240:255]
    v_mfma_f32_32x32x16_bf16 v[224:239], v[36:39], v[184:187], v[224:239]
    buffer_load_dwordx4 v[184:187], v4, s[12:15], s63 offen offset:0 sc1
    v_mfma_f32_32x32x16_bf16 v[208:223], v[40:43], v[180:183], v[208:223]
    buffer_load_dwordx4 v[40:43], v3, s[12:15], s63 offen offset:2048 sc1
    v_mfma_f32_32x32x16_bf16 v[192:207], v[36:39], v[180:183], v[192:207]
    buffer_load_dwordx4 v[36:39], v4, s[12:15], s63 offen offset:2048 sc1
    s_add_u32 s63, s61, 24576
    buffer_load_dwordx4 v[180:183], v3, s[12:15], s63 offen offset:0 sc1
    s_waitcnt vmcnt(15)
    v_mfma_f32_32x32x16_bf16 v[240:255], v[48:51], v[160:163], v[240:255]
    v_mfma_f32_32x32x16_bf16 v[224:239], v[44:47], v[160:163], v[224:239]
    buffer_load_dwordx4 v[160:163], v4, s[12:15], s63 offen offset:0 sc1
    v_mfma_f32_32x32x16_bf16 v[208:223], v[48:51], v[188:191], v[208:223]
    buffer_load_dwordx4 v[48:51], v3, s[12:15], s63 offen offset:2048 sc1
    v_mfma_f32_32x32x16_bf16 v[192:207], v[44:47], v[188:191], v[192:207]
    s_waitcnt vmcnt(15)
    buffer_load_dwordx4 v[44:47], v4, s[12:15], s63 offen offset:2048 sc1
    v_mfma_f32_32x32x16_bf16 v[240:255], v[56:59], v[12:15], v[240:255]
    v_mfma_f32_32x32x16_bf16 v[224:239], v[52:55], v[12:15], v[224:239]
    v_mfma_f32_32x32x16_bf16 v[208:223], v[56:59], v[16:19], v[208:223]
    v_mfma_f32_32x32x16_bf16 v[192:207], v[52:55], v[16:19], v[192:207]
    s_waitcnt vmcnt(14)
    s_add_u32 s63, s61, 28672
    buffer_load_dwordx4 v[188:191], v3, s[12:15], s63 offen offset:0 sc1
    buffer_load_dwordx4 v[12:15], v4, s[12:15], s63 offen offset:0 sc1
    v_mfma_f32_32x32x16_bf16 v[240:255], v[64:67], v[168:171], v[240:255]
    v_mfma_f32_32x32x16_bf16 v[224:239], v[60:63], v[168:171], v[224:239]
    v_mfma_f32_32x32x16_bf16 v[208:223], v[64:67], v[156:159], v[208:223]
    v_mfma_f32_32x32x16_bf16 v[192:207], v[60:63], v[156:159], v[192:207]
    s_waitcnt vmcnt(14)
    buffer_load_dwordx4 v[56:59], v3, s[12:15], s63 offen offset:2048 sc1
    buffer_load_dwordx4 v[52:55], v4, s[12:15], s63 offen offset:2048 sc1
    v_mfma_f32_32x32x16_bf16 v[240:255], v[72:75], v[20:23], v[240:255]
    v_mfma_f32_32x32x16_bf16 v[224:239], v[68:71], v[20:23], v[224:239]
    v_mfma_f32_32x32x16_bf16 v[208:223], v[72:75], v[24:27], v[208:223]
    v_mfma_f32_32x32x16_bf16 v[192:207], v[68:71], v[24:27], v[192:207]
    s_waitcnt vmcnt(14)
    s_add_u32 s63, s61, 32768
    buffer_load_dwordx4 v[16:19], v3, s[12:15], s63 offen offset:0 sc1
    v_mfma_f32_32x32x16_bf16 v[240:255], v[80:83], v[176:179], v[240:255]
    v_mfma_f32_32x32x16_bf16 v[224:239], v[76:79], v[176:179], v[224:239]
    v_mfma_f32_32x32x16_bf16 v[208:223], v[80:83], v[164:167], v[208:223]
    v_mfma_f32_32x32x16_bf16 v[192:207], v[76:79], v[164:167], v[192:207]
    s_waitcnt vmcnt(13)
    buffer_load_dwordx4 v[168:171], v4, s[12:15], s63 offen offset:0 sc1
    buffer_load_dwordx4 v[64:67], v3, s[12:15], s63 offen offset:2048 sc1
    v_mfma_f32_32x32x16_bf16 v[240:255], v[88:91], v[28:31], v[240:255]
    v_mfma_f32_32x32x16_bf16 v[224:239], v[84:87], v[28:31], v[224:239]
    v_mfma_f32_32x32x16_bf16 v[208:223], v[88:91], v[32:35], v[208:223]
    v_mfma_f32_32x32x16_bf16 v[192:207], v[84:87], v[32:35], v[192:207]
    s_waitcnt vmcnt(13)
    buffer_load_dwordx4 v[60:63], v4, s[12:15], s63 offen offset:2048 sc1
    v_mfma_f32_32x32x16_bf16 v[240:255], v[96:99], v[184:187], v[240:255]
    v_mfma_f32_32x32x16_bf16 v[224:239], v[92:95], v[184:187], v[224:239]
    v_mfma_f32_32x32x16_bf16 v[208:223], v[96:99], v[172:175], v[208:223]
    v_mfma_f32_32x32x16_bf16 v[192:207], v[92:95], v[172:175], v[192:207]
    s_waitcnt vmcnt(12)
    s_add_u32 s63, s61, 36864
    buffer_load_dwordx4 v[156:159], v3, s[12:15], s63 offen offset:0 sc1
    buffer_load_dwordx4 v[20:23], v4, s[12:15], s63 offen offset:0 sc1
    v_mfma_f32_32x32x16_bf16 v[240:255], v[104:107], v[36:39], v[240:255]
    v_mfma_f32_32x32x16_bf16 v[224:239], v[100:103], v[36:39], v[224:239]
    v_mfma_f32_32x32x16_bf16 v[208:223], v[104:107], v[40:43], v[208:223]
    v_mfma_f32_32x32x16_bf16 v[192:207], v[100:103], v[40:43], v[192:207]
    s_waitcnt vmcnt(12)
    buffer_load_dwordx4 v[72:75], v3, s[12:15], s63 offen offset:2048 sc1
    buffer_load_dwordx4 v[68:71], v4, s[12:15], s63 offen offset:2048 sc1
    v_mfma_f32_32x32x16_bf16 v[240:255], v[112:115], v[160:163], v[240:255]
    v_mfma_f32_32x32x16_bf16 v[224:239], v[108:111], v[160:163], v[224:239]
    v_mfma_f32_32x32x16_bf16 v[208:223], v[112:115], v[180:183], v[208:223]
    v_mfma_f32_32x32x16_bf16 v[192:207], v[108:111], v[180:183], v[192:207]
    s_waitcnt vmcnt(12)
    s_add_u32 s63, s61, 40960
    buffer_load_dwordx4 v[24:27], v3, s[12:15], s63 offen offset:0 sc1
    buffer_load_dwordx4 v[176:179], v4, s[12:15], s63 offen offset:0 sc1
    v_mfma_f32_32x32x16_bf16 v[240:255], v[120:123], v[44:47], v[240:255]
    v_mfma_f32_32x32x16_bf16 v[224:239], v[116:119], v[44:47], v[224:239]
    v_mfma_f32_32x32x16_bf16 v[208:223], v[120:123], v[48:51], v[208:223]
    v_mfma_f32_32x32x16_bf16 v[192:207], v[116:119], v[48:51], v[192:207]
    s_waitcnt vmcnt(12)
    buffer_load_dwordx4 v[80:83], v3, s[12:15], s63 offen offset:2048 sc1
    v_mfma_f32_32x32x16_bf16 v[240:255], v[128:131], v[12:15], v[240:255]
    v_mfma_f32_32x32x16_bf16 v[224:239], v[124:127], v[12:15], v[224:239]
    v_mfma_f32_32x32x16_bf16 v[208:223], v[128:131], v[188:191], v[208:223]
    v_mfma_f32_32x32x16_bf16 v[192:207], v[124:127], v[188:191], v[192:207]
    s_waitcnt vmcnt(11)
    buffer_load_dwordx4 v[76:79], v4, s[12:15], s63 offen offset:2048 sc1
    s_add_u32 s63, s61, 45056
    buffer_load_dwordx4 v[164:167], v3, s[12:15], s63 offen offset:0 sc1
    v_mfma_f32_32x32x16_bf16 v[240:255], v[136:139], v[52:55], v[240:255]
    v_mfma_f32_32x32x16_bf16 v[224:239], v[132:135], v[52:55], v[224:239]
    v_mfma_f32_32x32x16_bf16 v[208:223], v[136:139], v[56:59], v[208:223]
    v_mfma_f32_32x32x16_bf16 v[192:207], v[132:135], v[56:59], v[192:207]
    ds_read_b128 v[28:31], v1 offset:0
    ds_read_b128 v[88:91], v2 offset:0
    s_waitcnt vmcnt(11)
    buffer_load_dwordx4 v[84:87], v4, s[12:15], s63 offen offset:0 sc1
    v_mfma_f32_32x32x16_bf16 v[240:255], v[144:147], v[168:171], v[240:255]
    v_mfma_f32_32x32x16_bf16 v[224:239], v[140:143], v[168:171], v[224:239]
    v_mfma_f32_32x32x16_bf16 v[208:223], v[144:147], v[16:19], v[208:223]
    v_mfma_f32_32x32x16_bf16 v[192:207], v[140:143], v[16:19], v[192:207]
    ds_read_b128 v[32:35], v1 offset:2048
    ds_read_b128 v[184:187], v2 offset:2048
    s_waitcnt vmcnt(10)
    buffer_load_dwordx4 v[96:99], v3, s[12:15], s63 offen offset:2048 sc1
    buffer_load_dwordx4 v[92:95], v4, s[12:15], s63 offen offset:2048 sc1
    v_mfma_f32_32x32x16_bf16 v[240:255], v[152:155], v[60:63], v[240:255]
    v_mfma_f32_32x32x16_bf16 v[224:239], v[148:151], v[60:63], v[224:239]
    v_mfma_f32_32x32x16_bf16 v[208:223], v[152:155], v[64:67], v[208:223]
    v_mfma_f32_32x32x16_bf16 v[192:207], v[148:151], v[64:67], v[192:207]
    buffer_load_dwordx2 v[6:7], v5, s[12:15], s67 offen sc1
    ds_read_b128 v[172:175], v1 offset:4096
    ds_read_b128 v[36:39], v2 offset:4096
    s_waitcnt vmcnt(11) lgkmcnt(4)
    s_add_u32 s63, s61, 49152
    buffer_load_dwordx4 v[104:107], v3, s[12:15], s63 offen offset:0 sc1
    v_mfma_f32_32x32x16_bf16 v[240:255], v[88:91], v[20:23], v[240:255]
    v_mfma_f32_32x32x16_bf16 v[224:239], v[28:31], v[20:23], v[224:239]
    v_mfma_f32_32x32x16_bf16 v[208:223], v[88:91], v[156:159], v[208:223]
    v_mfma_f32_32x32x16_bf16 v[192:207], v[28:31], v[156:159], v[192:207]
    ds_read_b128 v[100:103], v1 offset:6144
    ds_read_b128 v[40:43], v2 offset:6144
    s_waitcnt vmcnt(10) lgkmcnt(4)
    buffer_load_dwordx4 v[160:163], v4, s[12:15], s63 offen offset:0 sc1
    v_mfma_f32_32x32x16_bf16 v[240:255], v[184:187], v[68:71], v[240:255]
    v_mfma_f32_32x32x16_bf16 v[224:239], v[32:35], v[68:71], v[224:239]
    v_mfma_f32_32x32x16_bf16 v[208:223], v[184:187], v[72:75], v[208:223]
    v_mfma_f32_32x32x16_bf16 v[192:207], v[32:35], v[72:75], v[192:207]
    ds_read_b128 v[112:115], v1 offset:8192
    ds_read_b128 v[108:111], v2 offset:8192
    s_waitcnt vmcnt(9) lgkmcnt(4)
    buffer_load_dwordx4 v[180:183], v3, s[12:15], s63 offen offset:2048 sc1
    buffer_load_dwordx4 v[44:47], v4, s[12:15], s63 offen offset:2048 sc1
    v_mfma_f32_32x32x16_bf16 v[240:255], v[36:39], v[176:179], v[240:255]
    v_mfma_f32_32x32x16_bf16 v[224:239], v[172:175], v[176:179], v[224:239]
    v_mfma_f32_32x32x16_bf16 v[208:223], v[36:39], v[24:27], v[208:223]
    v_mfma_f32_32x32x16_bf16 v[192:207], v[172:175], v[24:27], v[192:207]
    ds_read_b128 v[120:123], v1 offset:10240
    ds_read_b128 v[116:119], v2 offset:10240
    s_waitcnt vmcnt(9) lgkmcnt(4)
    s_add_u32 s63, s61, 53248
    buffer_load_dwordx4 v[48:51], v3, s[12:15], s63 offen offset:0 sc1
    buffer_load_dwordx4 v[12:15], v4, s[12:15], s63 offen offset:0 sc1
    v_mfma_f32_32x32x16_bf16 v[240:255], v[40:43], v[76:79], v[240:255]
    v_mfma_f32_32x32x16_bf16 v[224:239], v[100:103], v[76:79], v[224:239]
    v_mfma_f32_32x32x16_bf16 v[208:223], v[40:43], v[80:83], v[208:223]
    v_mfma_f32_32x32x16_bf16 v[192:207], v[100:103], v[80:83], v[192:207]
    ds_read_b128 v[128:131], v1 offset:12288
    ds_read_b128 v[124:127], v2 offset:12288
    s_waitcnt vmcnt(9) lgkmcnt(4)
    buffer_load_dwordx4 v[188:191], v3, s[12:15], s63 offen offset:2048 sc1
    v_mfma_f32_32x32x16_bf16 v[240:255], v[108:111], v[84:87], v[240:255]
    v_mfma_f32_32x32x16_bf16 v[224:239], v[112:115], v[84:87], v[224:239]
    v_mfma_f32_32x32x16_bf16 v[208:223], v[108:111], v[164:167], v[208:223]
    v_mfma_f32_32x32x16_bf16 v[192:207], v[112:115], v[164:167], v[192:207]
    s_waitcnt vmcnt(7)
    v_lshrrev_b32 v24, 2, v0
    v_lshlrev_b32 v24, 12, v24
    v_and_b32 v25, 3, v0
    v_lshl_add_u32 v24, v25, 4, v24
    s_lshl_b32 s62, s65, 12
    s_lshl_b32 s3, s64, 1
    s_add_u32 s62, s62, s3
    s_add_u32 s62, s62, 10485760
    s_add_u32 s54, s62, 0x10000
    v_and_b32 v9, 31, v0
    v_lshlrev_b32 v9, 2, v9
    s_lshl_b32 s55, s64, 2
    s_add_u32 s55, s55, 14680064
    v_cmp_ne_u64 vcc, s[100:101], v[6:7]
    s_nop 1
    s_cmp_eq_u64 vcc, 0
    s_cselect_b32 s1, 1, 0
    s_cbranch_scc0 Lat_no
    buffer_load_dwordx4 v[16:19], v24, s[12:15], s62 offen sc1
    buffer_load_dwordx4 v[20:23], v24, s[12:15], s54 offen sc1
    buffer_load_dword v8, v9, s[12:15], s55 offen sc1
    s_branch Lat_j
Lat_no:
    buffer_load_dwordx2 v[10:11], v5, s[12:15], s67 offen sc1
Lat_j:
    v_lshlrev_b32 v6, 4, v0
    v_add_u32 v32, s52, v6
    s_xor_b32 s3, s5, 1
    s_mul_i32 s10, s3, 20480
    s_add_u32 s10, s10, 65536
    v_add_u32 v33, s10, v6
    s_xor_b32 s3, s5, 2
    s_mul_i32 s10, s3, 20480
    s_add_u32 s10, s10, 65536
    v_add_u32 v34, s10, v6
    s_xor_b32 s3, s5, 3
    s_mul_i32 s10, s3, 20480
    s_add_u32 s10, s10, 65536
    v_add_u32 v35, s10, v6
    v_add_u32 v36, s53, v6
    v_bfe_u32 v26, v0, 2, 2
    v_lshrrev_b32 v25, 5, v0
    v_lshl_add_u32 v26, v25, 2, v26
    v_lshlrev_b32 v26, 6, v26
    v_bfe_u32 v27, v0, 4, 1
    v_lshl_add_u32 v26, v27, 5, v26
    v_and_b32 v27, 3, v0
    v_lshl_add_u32 v26, v27, 3, v26
    v_add_u32 v37, s53, v26
    v_and_b32 v26, 31, v0
    v_lshlrev_b32 v26, 10, v26
    v_lshl_add_u32 v38, v25, 4, v26
    s_lshl_b32 s66, s64, 10
    s_lshl_b32 s3, s65, 1
    s_add_u32 s66, s66, s3
    s_mov_b32 s56, s44
    s_and_b32 s57, s45, 0xffff
    s_mov_b32 s58, 2097152
    s_mov_b32 s59, 0x20000
    ds_read_b128 v[40:43], v1 offset:14336
    ds_read_b128 v[52:55], v2 offset:14336
    s_waitcnt lgkmcnt(4)
    buffer_load_dwordx4 v[56:59], v4, s[12:15], s63 offen offset:2048 sc1
    v_mfma_f32_32x32x16_bf16 v[240:255], v[116:119], v[92:95], v[240:255]
    v_mfma_f32_32x32x16_bf16 v[224:239], v[120:123], v[92:95], v[224:239]
    v_mfma_f32_32x32x16_bf16 v[208:223], v[116:119], v[96:99], v[208:223]
    v_mfma_f32_32x32x16_bf16 v[192:207], v[120:123], v[96:99], v[192:207]
    ds_read_b128 v[60:63], v1 offset:16384
    ds_read_b128 v[64:67], v2 offset:16384
    ds_read_b128 v[68:71], v1 offset:18432
    ds_read_b128 v[72:75], v2 offset:18432
    s_waitcnt vmcnt(7) lgkmcnt(6)
    v_mfma_f32_32x32x16_bf16 v[240:255], v[124:127], v[160:163], v[240:255]
    v_mfma_f32_32x32x16_bf16 v[224:239], v[128:131], v[160:163], v[224:239]
    v_mfma_f32_32x32x16_bf16 v[208:223], v[124:127], v[104:107], v[208:223]
    v_mfma_f32_32x32x16_bf16 v[192:207], v[128:131], v[104:107], v[192:207]
    s_waitcnt vmcnt(5) lgkmcnt(4)
    v_mfma_f32_32x32x16_bf16 v[240:255], v[52:55], v[44:47], v[240:255]
    s_waitcnt vmcnt(3) lgkmcnt(2)
    v_mfma_f32_32x32x16_bf16 v[240:255], v[64:67], v[12:15], v[240:255]
    s_waitcnt vmcnt(0) lgkmcnt(0)
    v_mfma_f32_32x32x16_bf16 v[240:255], v[72:75], v[56:59], v[240:255]
    v_mfma_f32_32x32x16_bf16 v[224:239], v[40:43], v[44:47], v[224:239]
    v_mfma_f32_32x32x16_bf16 v[224:239], v[60:63], v[12:15], v[224:239]
    v_mfma_f32_32x32x16_bf16 v[224:239], v[68:71], v[56:59], v[224:239]
    v_mfma_f32_32x32x16_bf16 v[208:223], v[52:55], v[180:183], v[208:223]
    s_nop 7
    ds_write_b128 v32, v[240:243] offset:8192
    ds_write_b128 v32, v[244:247] offset:9216
    v_mfma_f32_32x32x16_bf16 v[208:223], v[64:67], v[48:51], v[208:223]
    ds_write_b128 v32, v[248:251] offset:10240
    ds_write_b128 v32, v[252:255] offset:11264
    v_mfma_f32_32x32x16_bf16 v[208:223], v[72:75], v[188:191], v[208:223]
    v_mfma_f32_32x32x16_bf16 v[192:207], v[40:43], v[180:183], v[192:207]
    ds_write_b128 v32, v[224:227] offset:4096
    ds_write_b128 v32, v[228:231] offset:5120
    v_mfma_f32_32x32x16_bf16 v[192:207], v[60:63], v[48:51], v[192:207]
    ds_write_b128 v32, v[232:235] offset:6144
    ds_write_b128 v32, v[236:239] offset:7168
    v_mfma_f32_32x32x16_bf16 v[192:207], v[68:71], v[188:191], v[192:207]
    s_cmp_eq_u32 s1, 1
    s_cbranch_scc1 Lat_have
    s_waitcnt vmcnt(0)
    v_cmp_ne_u64 vcc, s[100:101], v[10:11]
    s_nop 1
    s_cmp_eq_u64 vcc, 0
    s_cbranch_scc1 Lp_a_ok
    s_mov_b32 s10, 0
Lp_a:
    buffer_load_dwordx2 v[10:11], v5, s[12:15], s67 offen sc1
    s_waitcnt vmcnt(0)
    v_cmp_ne_u64 vcc, s[100:101], v[10:11]
    s_nop 1
    s_cmp_eq_u64 vcc, 0
    s_cbranch_scc1 Lp_a_ok
    s_add_u32 s10, s10, 1
    s_sleep 1
    s_cmp_lt_u32 s10, 30000
    s_cbranch_scc1 Lp_a
Lp_a_ok:
    buffer_load_dwordx4 v[16:19], v24, s[12:15], s62 offen sc1
    buffer_load_dwordx4 v[20:23], v24, s[12:15], s54 offen sc1
    buffer_load_dword v8, v9, s[12:15], s55 offen sc1
Lat_have:
    s_nop 7
    s_waitcnt vmcnt(0)
    ds_write_b128 v36, v[16:19]
    ds_write_b128 v36, v[20:23] offset:1024
    ds_read_b64_tr_b16 v[84:85], v37 offset:0
    ds_read_b64_tr_b16 v[86:87], v37 offset:512
    ds_read_b64_tr_b16 v[88:89], v37 offset:1024
    ds_read_b64_tr_b16 v[90:91], v37 offset:1536
    ds_write_b128 v32, v[208:211] offset:0
    ds_write_b128 v32, v[212:215] offset:1024
    ds_write_b128 v32, v[216:219] offset:2048
    ds_write_b128 v32, v[220:223] offset:3072
    v_sub_f32 v28, 1.0, v8
    v_cvt_pk_bf16_f32 v28, 0, v28
    v_mov_b32 v29, v28
    v_mov_b32 v30, v8
    v_mov_b32 v31, v8
    s_waitcnt lgkmcnt(4)
    v_lshlrev_b32 v92, 16, v84
    v_and_b32 v93, 0xffff0000, v84
    v_lshlrev_b32 v94, 16, v85
    v_and_b32 v95, 0xffff0000, v85
    v_mul_f32 v92, v30, v92
    v_mul_f32 v93, v31, v93
    v_mul_f32 v94, v30, v94
    v_mul_f32 v95, v31, v95
    v_cvt_pk_bf16_f32 v92, 0, v92
    v_cvt_pk_bf16_f32 v93, 0, v93
    v_cvt_pk_bf16_f32 v94, 0, v94
    v_cvt_pk_bf16_f32 v95, 0, v95
    v_lshlrev_b32 v96, 16, v86
    v_and_b32 v97, 0xffff0000, v86
    v_lshlrev_b32 v98, 16, v87
    v_and_b32 v99, 0xffff0000, v87
    v_mul_f32 v96, v30, v96
    v_mul_f32 v97, v31, v97
    v_mul_f32 v98, v30, v98
    v_mul_f32 v99, v31, v99
    v_cvt_pk_bf16_f32 v96, 0, v96
    v_cvt_pk_bf16_f32 v97, 0, v97
    v_cvt_pk_bf16_f32 v98, 0, v98
    v_cvt_pk_bf16_f32 v99, 0, v99
    v_lshlrev_b32 v100, 16, v88
    v_and_b32 v101, 0xffff0000, v88
    v_lshlrev_b32 v102, 16, v89
    v_and_b32 v103, 0xffff0000, v89
    v_mul_f32 v100, v30, v100
    v_mul_f32 v101, v31, v101
    v_mul_f32 v102, v30, v102
    v_mul_f32 v103, v31, v103
    v_cvt_pk_bf16_f32 v100, 0, v100
    v_cvt_pk_bf16_f32 v101, 0, v101
    v_cvt_pk_bf16_f32 v102, 0, v102
    v_cvt_pk_bf16_f32 v103, 0, v103
    v_lshlrev_b32 v104, 16, v90
    v_and_b32 v105, 0xffff0000, v90
    v_lshlrev_b32 v106, 16, v91
    v_and_b32 v107, 0xffff0000, v91
    v_mul_f32 v104, v30, v104
    v_mul_f32 v105, v31, v105
    v_mul_f32 v106, v30, v106
    v_mul_f32 v107, v31, v107
    v_cvt_pk_bf16_f32 v104, 0, v104
    v_cvt_pk_bf16_f32 v105, 0, v105
    v_cvt_pk_bf16_f32 v106, 0, v106
    v_cvt_pk_bf16_f32 v107, 0, v107
    s_waitcnt lgkmcnt(0)
    s_barrier
    ds_read_b128 v[12:15], v33 offset:0
    ds_read_b128 v[52:55], v34 offset:4096
    ds_read_b128 v[68:71], v35 offset:8192
    ds_read_b128 v[40:43], v33 offset:1024
    ds_read_b128 v[56:59], v34 offset:5120
    ds_read_b128 v[72:75], v35 offset:9216
    ds_read_b128 v[44:47], v33 offset:2048
    ds_read_b128 v[60:63], v34 offset:6144
    ds_read_b128 v[76:79], v35 offset:10240
    ds_read_b128 v[48:51], v33 offset:3072
    ds_read_b128 v[64:67], v34 offset:7168
    ds_read_b128 v[80:83], v35 offset:11264
    s_waitcnt lgkmcnt(9)
    v_add_f32 v192, v12, v192
    v_add_f32 v193, v13, v193
    v_add_f32 v52, v68, v52
    v_add_f32 v53, v69, v53
    v_add_f32 v194, v14, v194
    v_add_f32 v195, v15, v195
    v_add_f32 v54, v70, v54
    v_add_f32 v55, v71, v55
    v_add_f32 v192, v52, v192
    v_add_f32 v193, v53, v193
    v_add_f32 v194, v54, v194
    v_add_f32 v195, v55, v195
    v_cvt_pk_bf16_f32 v192, 0, v192
    v_cvt_pk_bf16_f32 v193, 0, v193
    v_cvt_pk_bf16_f32 v194, 0, v194
    v_cvt_pk_bf16_f32 v195, 0, v195
    v_mul_f32 v192, v28, v192
    v_mul_f32 v193, v29, v193
    v_mul_f32 v194, v28, v194
    v_mul_f32 v195, v29, v195
    v_cvt_pk_bf16_f32 v192, 0, v192
    v_cvt_pk_bf16_f32 v193, 0, v193
    v_cvt_pk_bf16_f32 v194, 0, v194
    v_cvt_pk_bf16_f32 v195, 0, v195
    v_add_f32 v192, v92, v192
    v_add_f32 v193, v93, v193
    v_add_f32 v194, v94, v194
    v_add_f32 v195, v95, v195
    v_cvt_pk_bf16_f32 v12, v192, v193
    v_cvt_pk_bf16_f32 v13, v194, v195
    s_waitcnt lgkmcnt(6)
    v_add_f32 v196, v40, v196
    v_add_f32 v197, v41, v197
    v_add_f32 v56, v72, v56
    v_add_f32 v57, v73, v57
    v_add_f32 v198, v42, v198
    v_add_f32 v199, v43, v199
    v_add_f32 v58, v74, v58
    v_add_f32 v59, v75, v59
    v_add_f32 v196, v56, v196
    v_add_f32 v197, v57, v197
    v_add_f32 v198, v58, v198
    v_add_f32 v199, v59, v199
    v_cvt_pk_bf16_f32 v196, 0, v196
    v_cvt_pk_bf16_f32 v197, 0, v197
    v_cvt_pk_bf16_f32 v198, 0, v198
    v_cvt_pk_bf16_f32 v199, 0, v199
    v_mul_f32 v196, v28, v196
    v_mul_f32 v197, v29, v197
    v_mul_f32 v198, v28, v198
    v_mul_f32 v199, v29, v199
    v_cvt_pk_bf16_f32 v196, 0, v196
    v_cvt_pk_bf16_f32 v197, 0, v197
    v_cvt_pk_bf16_f32 v198, 0, v198
    v_cvt_pk_bf16_f32 v199, 0, v199
    v_add_f32 v196, v96, v196
    v_add_f32 v197, v97, v197
    v_add_f32 v198, v98, v198
    v_add_f32 v199, v99, v199
    v_cvt_pk_bf16_f32 v14, v196, v197
    v_cvt_pk_bf16_f32 v15, v198, v199
    s_nop 0
    v_permlane32_swap_b32 v12, v14
    v_permlane32_swap_b32 v13, v15
    buffer_store_dwordx4 v[12:15], v38, s[56:59], s66 offen offset:0
    s_waitcnt lgkmcnt(3)
    v_add_f32 v200, v44, v200
    v_add_f32 v201, v45, v201
    v_add_f32 v60, v76, v60
    v_add_f32 v61, v77, v61
    v_add_f32 v202, v46, v202
    v_add_f32 v203, v47, v203
    v_add_f32 v62, v78, v62
    v_add_f32 v63, v79, v63
    v_add_f32 v200, v60, v200
    v_add_f32 v201, v61, v201
    v_add_f32 v202, v62, v202
    v_add_f32 v203, v63, v203
    v_cvt_pk_bf16_f32 v200, 0, v200
    v_cvt_pk_bf16_f32 v201, 0, v201
    v_cvt_pk_bf16_f32 v202, 0, v202
    v_cvt_pk_bf16_f32 v203, 0, v203
    v_mul_f32 v200, v28, v200
    v_mul_f32 v201, v29, v201
    v_mul_f32 v202, v28, v202
    v_mul_f32 v203, v29, v203
    v_cvt_pk_bf16_f32 v200, 0, v200
    v_cvt_pk_bf16_f32 v201, 0, v201
    v_cvt_pk_bf16_f32 v202, 0, v202
    v_cvt_pk_bf16_f32 v203, 0, v203
    v_add_f32 v200, v100, v200
    v_add_f32 v201, v101, v201
    v_add_f32 v202, v102, v202
    v_add_f32 v203, v103, v203
    v_cvt_pk_bf16_f32 v44, v200, v201
    v_cvt_pk_bf16_f32 v45, v202, v203
    s_waitcnt lgkmcnt(0)
    v_add_f32 v204, v48, v204
    v_add_f32 v205, v49, v205
    v_add_f32 v64, v80, v64
    v_add_f32 v65, v81, v65
    v_add_f32 v206, v50, v206
    v_add_f32 v207, v51, v207
    v_add_f32 v66, v82, v66
    v_add_f32 v67, v83, v67
    v_add_f32 v204, v64, v204
    v_add_f32 v205, v65, v205
    v_add_f32 v206, v66, v206
    v_add_f32 v207, v67, v207
    v_cvt_pk_bf16_f32 v204, 0, v204
    v_cvt_pk_bf16_f32 v205, 0, v205
    v_cvt_pk_bf16_f32 v206, 0, v206
    v_cvt_pk_bf16_f32 v207, 0, v207
    v_mul_f32 v204, v28, v204
    v_mul_f32 v205, v29, v205
    v_mul_f32 v206, v28, v206
    v_mul_f32 v207, v29, v207
    v_cvt_pk_bf16_f32 v204, 0, v204
    v_cvt_pk_bf16_f32 v205, 0, v205
    v_cvt_pk_bf16_f32 v206, 0, v206
    v_cvt_pk_bf16_f32 v207, 0, v207
    v_add_f32 v204, v104, v204
    v_add_f32 v205, v105, v205
    v_add_f32 v206, v106, v206
    v_add_f32 v207, v107, v207
    v_cvt_pk_bf16_f32 v46, v204, v205
    v_cvt_pk_bf16_f32 v47, v206, v207
    s_nop 0
    v_permlane32_swap_b32 v44, v46
    v_permlane32_swap_b32 v45, v47
    buffer_store_dwordx4 v[44:47], v38, s[56:59], s66 offen offset:32
    s_endpgm
Lrole_M:
    s_lshr_b32 s10, s5, 1
    s_lshl_b32 s54, s6, 1
    s_add_u32 s54, s54, s10
    s_and_b32 s55, s5, 1
    s_lshl_b32 s52, s54, 4
    s_add_u32 s52, s52, s7
    s_lshl_b32 s52, s52, 1
    s_add_u32 s52, s52, s55
    s_lshl_b32 s52, s52, 7
    s_add_u32 s52, s52, 14942208
    s_lshl_b32 s56, s2, 1
    s_add_u32 s56, s56, s10
    s_lshr_b32 s53, s56, 6
    s_lshl_b32 s53, s53, 1
    s_add_u32 s53, s53, s55
    s_lshl_b32 s53, s53, 6
    s_and_b32 s3, s56, 63
    s_add_u32 s53, s53, s3
    s_lshl_b32 s53, s53, 4
    s_add_u32 s53, s53, 15073280
    v_cmp_gt_u32 vcc, 16, v0
    v_mov_b32 v2, 0x7fffffff
    v_lshlrev_b32 v19, 3, v0
    v_cndmask_b32 v19, v2, v19, vcc
    v_cmp_gt_u32 vcc, 2, v0
    v_mov_b32 v2, 0x7fffffff
    v_lshlrev_b32 v29, 3, v0
    v_cndmask_b32 v29, v2, v29, vcc
    v_mov_b32 v18, 1
    v_lshlrev_b32 v15, 4, v0
    s_mov_b32 s12, s48
    s_and_b32 s13, s49, 0xffff
    s_mov_b32 s14, 268435456
    s_mov_b32 s15, 0x20000
    s_lshl_b32 s3, s2, 2
    s_add_u32 s3, s3, s5
    s_lshl_b32 s3, s3, 7
    s_add_u32 s3, s3, 14696448
    s_cmp_ge_u32 s2, 224
    s_cselect_b32 s3, s3, s52
    buffer_store_dwordx2 v[156:157], v19, s[12:15], s3 offen sc1
    buffer_store_dwordx2 v[156:157], v29, s[12:15], s53 offen sc1
    v_and_b32 v1, 15, v0
    v_lshrrev_b32 v2, 4, v0
    v_lshrrev_b32 v3, 1, v1
    v_xor_b32 v3, v3, v2
    v_lshlrev_b32 v3, 4, v3
    v_lshl_add_u32 v3, v1, 7, v3
    s_lshl_b32 s3, s10, 13
    s_add_u32 s3, s3, 49152
    v_add_u32 v5, s3, v3
    v_xor_b32 v6, 64, v5
    v_bfe_u32 v3, v0, 2, 3
    s_lshl_b32 s3, s55, 2
    v_xor_b32 v3, s3, v3
    v_bfe_u32 v4, v0, 2, 2
    v_lshl_add_u32 v4, v2, 3, v4
    v_lshlrev_b32 v4, 8, v4
    v_and_b32 v1, 3, v0
    v_lshl_add_u32 v4, v1, 3, v4
    v_lshl_add_u32 v4, v3, 5, v4
    v_xor_b32 v1, 0, v4
    v_add_u32 v7, 98304, v1
    v_add_u32 v11, 16384, v1
    v_xor_b32 v1, 32, v4
    v_add_u32 v8, 98304, v1
    v_add_u32 v12, 16384, v1
    v_xor_b32 v1, 64, v4
    v_add_u32 v9, 98304, v1
    v_add_u32 v13, 16384, v1
    v_xor_b32 v1, 96, v4
    v_add_u32 v10, 98304, v1
    v_add_u32 v14, 16384, v1
    s_mul_i32 s60, s54, 229376
    s_lshl_b32 s3, s7, 14
    s_add_u32 s60, s60, s3
    s_lshl_b32 s3, s55, 13
    s_add_u32 s60, s60, s3
    s_add_u32 s61, s60, 4096
    s_mul_i32 s3, s10, 18560
    s_lshl_b32 s11, s55, 8
    s_add_u32 s3, s3, s11
    s_add_u32 s3, s3, 16768
    v_and_b32 v1, 3, v0
    v_mul_u32_u24 v1, 4640, v1
    v_bfe_u32 v3, v0, 2, 2
    v_lshlrev_b32 v3, 7, v3
    v_sub_u32 v1, v1, v3
    v_lshlrev_b32 v2, 4, v2
    v_add3_u32 v20, v1, v2, s3
    s_mul_i32 s65, s10, 4224
    s_add_u32 s65, s65, 7936
    s_add_u32 s3, s65, s11
    s_add_u32 s3, s3, 8
    v_and_b32 v1, 15, v0
    v_lshlrev_b32 v1, 3, v1
    v_add3_u32 v21, v1, v2, s3
    s_lshl_b32 s3, s5, 12
    s_add_u32 s66, s3, 147456
    v_add_u32 v23, s66, v15
    v_xor_b32 v22, 0x1000, v23
    s_lshl_b32 s3, s55, 11
    s_add_u32 s3, s3, s65
    s_add_u32 s3, s3, 128
    v_lshl_add_u32 v24, v0, 3, s3
    s_lshl_b32 s3, s5, 2
    v_mov_b32 v25, s3
    v_mov_b32 v26, 0
    s_lshl_b32 s3, s10, 2
    v_mov_b32 v27, s3
    v_min_u32 v28, 3, v0
    v_lshlrev_b32 v28, 2, v28
    s_mul_i32 s62, s10, 3200
    s_add_u32 s3, s65, 1024
    s_cmp_eq_u32 s55, 0
    s_cselect_b32 s62, s62, s3
    s_waitcnt lgkmcnt(0)
    s_lshl_b32 s3, s51, 16
    s_and_b32 s10, s51, 0xffff0000
    s_cmp_lt_u32 s5, 2
    s_cselect_b32 s58, s3, s10
    s_mov_b32 s59, s58
    s_mul_i32 s57, s5, 4608
    s_add_u32 s57, s57, 16384
    v_and_b32 v1, 15, v0
    v_lshrrev_b32 v2, 4, v0
    v_lshlrev_b32 v2, 4, v2
    v_add_u32 v2, s57, v2
    v_mul_u32_u24 v3, 288, v1
    v_add_u32 v38, v3, v2
    v_lshl_add_u32 v39, v1, 6, v2
    s_sub_u32 s3, s62, s57
    v_add_u32 v39, s3, v39
    v_lshl_add_u32 v41, v0, 2, s57
    v_add_u32 v42, 1152, v41
    v_add_u32 v43, 2304, v41
    v_add_u32 v44, 3456, v41
    s_lshl_b32 s3, s50, 16
    s_and_b32 s10, s50, 0xffff0000
    s_cmp_lt_u32 s5, 2
    s_cselect_b32 s50, s3, s10
    s_mov_b32 s10, 0x3fb8aa3b
    v_mov_b32 v1, s50
    v_mul_f32 v2, s10, v1
    v_fma_f32 v3, v1, s10, -v2
    v_mul_f32 v4, 0x32a57060, v1
    v_add_f32 v3, v3, v4
    v_exp_f32 v2, v2
    v_mul_f32 v3, 0x3f317218, v3
    v_fma_f32 v2, v2, v3, v2
    v_cvt_pk_bf16_f32 v40, 0, v2
    s_waitcnt vmcnt(2)
    v_lshlrev_b32 v32, 16, v32
    v_lshlrev_b32 v33, 16, v33
    v_lshlrev_b32 v34, 16, v34
    v_lshlrev_b32 v35, 16, v35
    v_lshlrev_b32 v36, 16, v36
    v_lshlrev_b32 v37, 16, v37
    v_mul_f32 v32, v40, v32
    v_mul_f32 v33, v40, v33
    v_mul_f32 v34, v40, v34
    v_mul_f32 v35, v40, v35
    v_mul_f32 v32, s10, v32
    v_mul_f32 v33, 0.15915494, v33
    v_mul_f32 v45, 0x41000000, v32
    v_mul_f32 v46, 0x41000000, v33
    v_exp_f32 v45, v45
    v_fract_f32 v46, v46
    v_exp_f32 v48, v32
    v_fract_f32 v49, v33
    v_mul_f32 v51, 0x43000000, v32
    v_mul_f32 v52, 0x43000000, v33
    v_exp_f32 v51, v51
    v_fract_f32 v52, v52
    v_sin_f32 v47, v46
    v_cos_f32 v46, v46
    v_sin_f32 v50, v49
    v_cos_f32 v49, v49
    v_sin_f32 v53, v52
    v_cos_f32 v52, v52
    v_mul_f32 v60, v36, v34
    v_mul_f32 v61, v36, v35
    v_fma_f32 v60, -v37, v35, v60
    v_fma_f32 v61, -v37, v34, -v61
    v_mul_f32 v54, v45, v46
    v_mul_f32 v55, -v45, v47
    v_mul_f32 v56, v48, v49
    v_mul_f32 v57, v48, v50
    v_mul_f32 v58, v51, v52
    v_mul_f32 v59, v51, v53
    v_pk_mul_f32 v[62:63], v[60:61], v[54:55] op_sel_hi:[0,1]
    v_pk_fma_f32 v[62:63], v[60:61], v[54:55], v[62:63] op_sel:[1,1,0] op_sel_hi:[1,0,1] neg_lo:[1,0,0]
    v_cvt_pk_bf16_f32 v64, v60, v61
    v_pk_mul_f32 v[60:61], v[62:63], v[54:55] op_sel_hi:[0,1]
    v_pk_fma_f32 v[60:61], v[62:63], v[54:55], v[60:61] op_sel:[1,1,0] op_sel_hi:[1,0,1] neg_lo:[1,0,0]
    v_cvt_pk_bf16_f32 v65, v62, v63
    ds_write2_b32 v41, v64, v65 offset0:0 offset1:72
    v_pk_mul_f32 v[62:63], v[60:61], v[54:55] op_sel_hi:[0,1]
    v_pk_fma_f32 v[62:63], v[60:61], v[54:55], v[62:63] op_sel:[1,1,0] op_sel_hi:[1,0,1] neg_lo:[1,0,0]
    v_cvt_pk_bf16_f32 v66, v60, v61
    v_pk_mul_f32 v[60:61], v[62:63], v[54:55] op_sel_hi:[0,1]
    v_pk_fma_f32 v[60:61], v[62:63], v[54:55], v[60:61] op_sel:[1,1,0] op_sel_hi:[1,0,1] neg_lo:[1,0,0]
    v_cvt_pk_bf16_f32 v67, v62, v63
    ds_write2_b32 v41, v66, v67 offset0:144 offset1:216
    v_pk_mul_f32 v[62:63], v[60:61], v[54:55] op_sel_hi:[0,1]
    v_pk_fma_f32 v[62:63], v[60:61], v[54:55], v[62:63] op_sel:[1,1,0] op_sel_hi:[1,0,1] neg_lo:[1,0,0]
    v_cvt_pk_bf16_f32 v64, v60, v61
    v_pk_mul_f32 v[60:61], v[62:63], v[54:55] op_sel_hi:[0,1]
    v_pk_fma_f32 v[60:61], v[62:63], v[54:55], v[60:61] op_sel:[1,1,0] op_sel_hi:[1,0,1] neg_lo:[1,0,0]
    v_cvt_pk_bf16_f32 v65, v62, v63
    ds_write2_b32 v42, v64, v65 offset0:0 offset1:72
    v_pk_mul_f32 v[62:63], v[60:61], v[54:55] op_sel_hi:[0,1]
    v_pk_fma_f32 v[62:63], v[60:61], v[54:55], v[62:63] op_sel:[1,1,0] op_sel_hi:[1,0,1] neg_lo:[1,0,0]
    v_cvt_pk_bf16_f32 v66, v60, v61
    v_pk_mul_f32 v[60:61], v[62:63], v[54:55] op_sel_hi:[0,1]
    v_pk_fma_f32 v[60:61], v[62:63], v[54:55], v[60:61] op_sel:[1,1,0] op_sel_hi:[1,0,1] neg_lo:[1,0,0]
    v_cvt_pk_bf16_f32 v67, v62, v63
    ds_write2_b32 v42, v66, v67 offset0:144 offset1:216
    v_pk_mul_f32 v[62:63], v[60:61], v[54:55] op_sel_hi:[0,1]
    v_pk_fma_f32 v[62:63], v[60:61], v[54:55], v[62:63] op_sel:[1,1,0] op_sel_hi:[1,0,1] neg_lo:[1,0,0]
    v_cvt_pk_bf16_f32 v64, v60, v61
    v_pk_mul_f32 v[60:61], v[62:63], v[54:55] op_sel_hi:[0,1]
    v_pk_fma_f32 v[60:61], v[62:63], v[54:55], v[60:61] op_sel:[1,1,0] op_sel_hi:[1,0,1] neg_lo:[1,0,0]
    v_cvt_pk_bf16_f32 v65, v62, v63
    ds_write2_b32 v43, v64, v65 offset0:0 offset1:72
    v_pk_mul_f32 v[62:63], v[60:61], v[54:55] op_sel_hi:[0,1]
    v_pk_fma_f32 v[62:63], v[60:61], v[54:55], v[62:63] op_sel:[1,1,0] op_sel_hi:[1,0,1] neg_lo:[1,0,0]
    v_cvt_pk_bf16_f32 v66, v60, v61
    v_pk_mul_f32 v[60:61], v[62:63], v[54:55] op_sel_hi:[0,1]
    v_pk_fma_f32 v[60:61], v[62:63], v[54:55], v[60:61] op_sel:[1,1,0] op_sel_hi:[1,0,1] neg_lo:[1,0,0]
    v_cvt_pk_bf16_f32 v67, v62, v63
    ds_write2_b32 v43, v66, v67 offset0:144 offset1:216
    v_pk_mul_f32 v[62:63], v[60:61], v[54:55] op_sel_hi:[0,1]
    v_pk_fma_f32 v[62:63], v[60:61], v[54:55], v[62:63] op_sel:[1,1,0] op_sel_hi:[1,0,1] neg_lo:[1,0,0]
    v_cvt_pk_bf16_f32 v64, v60, v61
    v_pk_mul_f32 v[60:61], v[62:63], v[54:55] op_sel_hi:[0,1]
    v_pk_fma_f32 v[60:61], v[62:63], v[54:55], v[60:61] op_sel:[1,1,0] op_sel_hi:[1,0,1] neg_lo:[1,0,0]
    v_cvt_pk_bf16_f32 v65, v62, v63
    ds_write2_b32 v44, v64, v65 offset0:0 offset1:72
    v_pk_mul_f32 v[62:63], v[60:61], v[54:55] op_sel_hi:[0,1]
    v_pk_fma_f32 v[62:63], v[60:61], v[54:55], v[62:63] op_sel:[1,1,0] op_sel_hi:[1,0,1] neg_lo:[1,0,0]
    v_cvt_pk_bf16_f32 v66, v60, v61
    v_cvt_pk_bf16_f32 v67, v62, v63
    ds_write2_b32 v44, v66, v67 offset0:144 offset1:216
    ds_read_b128 v[88:91], v38 offset:0
    ds_read_b128 v[92:95], v38 offset:64
    ds_read_b128 v[96:99], v38 offset:128
    ds_read_b128 v[100:103], v38 offset:192
    v_mov_b32 v64, 0x3f80
    v_pk_mul_f32 v[68:69], v[56:57], v[56:57] op_sel_hi:[0,1]
    v_pk_fma_f32 v[68:69], v[56:57], v[56:57], v[68:69] op_sel:[1,1,0] op_sel_hi:[1,0,1] neg_lo:[1,0,0]
    v_cvt_pk_bf16_f32 v65, v56, v57
    ds_write2_b32 v41, v64, v65 offset0:0 offset1:72
    v_pk_mul_f32 v[70:71], v[68:69], v[56:57] op_sel_hi:[0,1]
    v_pk_fma_f32 v[70:71], v[68:69], v[56:57], v[70:71] op_sel:[1,1,0] op_sel_hi:[1,0,1] neg_lo:[1,0,0]
    v_cvt_pk_bf16_f32 v66, v68, v69
    v_pk_mul_f32 v[72:73], v[70:71], v[56:57] op_sel_hi:[0,1]
    v_pk_fma_f32 v[72:73], v[70:71], v[56:57], v[72:73] op_sel:[1,1,0] op_sel_hi:[1,0,1] neg_lo:[1,0,0]
    v_cvt_pk_bf16_f32 v67, v70, v71
    ds_write2_b32 v41, v66, v67 offset0:144 offset1:216
    v_pk_mul_f32 v[74:75], v[72:73], v[56:57] op_sel_hi:[0,1]
    v_pk_fma_f32 v[74:75], v[72:73], v[56:57], v[74:75] op_sel:[1,1,0] op_sel_hi:[1,0,1] neg_lo:[1,0,0]
    v_cvt_pk_bf16_f32 v64, v72, v73
    v_pk_mul_f32 v[76:77], v[74:75], v[56:57] op_sel_hi:[0,1]
    v_pk_fma_f32 v[76:77], v[74:75], v[56:57], v[76:77] op_sel:[1,1,0] op_sel_hi:[1,0,1] neg_lo:[1,0,0]
    v_cvt_pk_bf16_f32 v65, v74, v75
    ds_write2_b32 v42, v64, v65 offset0:0 offset1:72
    v_pk_mul_f32 v[78:79], v[76:77], v[56:57] op_sel_hi:[0,1]
    v_pk_fma_f32 v[78:79], v[76:77], v[56:57], v[78:79] op_sel:[1,1,0] op_sel_hi:[1,0,1] neg_lo:[1,0,0]
    v_cvt_pk_bf16_f32 v66, v76, v77
    v_cvt_pk_bf16_f32 v67, v78, v79
    ds_write2_b32 v42, v66, v67 offset0:144 offset1:216
    v_pk_mul_f32 v[86:87], v[58:59], v[56:57] op_sel_hi:[0,1]
    v_pk_fma_f32 v[86:87], v[58:59], v[56:57], v[86:87] op_sel:[1,1,0] op_sel_hi:[1,0,1] neg_lo:[1,0,0]
    v_cvt_pk_bf16_f32 v64, v58, v59
    v_pk_mul_f32 v[84:85], v[58:59], v[68:69] op_sel_hi:[0,1]
    v_pk_fma_f32 v[84:85], v[58:59], v[68:69], v[84:85] op_sel:[1,1,0] op_sel_hi:[1,0,1] neg_lo:[1,0,0]
    v_cvt_pk_bf16_f32 v65, v86, v87
    ds_write2_b32 v43, v64, v65 offset0:0 offset1:72
    v_pk_mul_f32 v[86:87], v[58:59], v[70:71] op_sel_hi:[0,1]
    v_pk_fma_f32 v[86:87], v[58:59], v[70:71], v[86:87] op_sel:[1,1,0] op_sel_hi:[1,0,1] neg_lo:[1,0,0]
    v_cvt_pk_bf16_f32 v66, v84, v85
    v_pk_mul_f32 v[84:85], v[58:59], v[72:73] op_sel_hi:[0,1]
    v_pk_fma_f32 v[84:85], v[58:59], v[72:73], v[84:85] op_sel:[1,1,0] op_sel_hi:[1,0,1] neg_lo:[1,0,0]
    v_cvt_pk_bf16_f32 v67, v86, v87
    ds_write2_b32 v43, v66, v67 offset0:144 offset1:216
    v_pk_mul_f32 v[86:87], v[58:59], v[74:75] op_sel_hi:[0,1]
    v_pk_fma_f32 v[86:87], v[58:59], v[74:75], v[86:87] op_sel:[1,1,0] op_sel_hi:[1,0,1] neg_lo:[1,0,0]
    v_cvt_pk_bf16_f32 v64, v84, v85
    v_pk_mul_f32 v[84:85], v[58:59], v[76:77] op_sel_hi:[0,1]
    v_pk_fma_f32 v[84:85], v[58:59], v[76:77], v[84:85] op_sel:[1,1,0] op_sel_hi:[1,0,1] neg_lo:[1,0,0]
    v_cvt_pk_bf16_f32 v65, v86, v87
    ds_write2_b32 v44, v64, v65 offset0:0 offset1:72
    v_pk_mul_f32 v[86:87], v[58:59], v[78:79] op_sel_hi:[0,1]
    v_pk_fma_f32 v[86:87], v[58:59], v[78:79], v[86:87] op_sel:[1,1,0] op_sel_hi:[1,0,1] neg_lo:[1,0,0]
    v_cvt_pk_bf16_f32 v66, v84, v85
    v_cvt_pk_bf16_f32 v67, v86, v87
    ds_write2_b32 v44, v66, v67 offset0:144 offset1:216
    ds_read_b128 v[104:107], v38 offset:0
    ds_read_b128 v[108:111], v38 offset:64
    ds_read_b128 v[112:115], v38 offset:128
    ds_read_b128 v[116:119], v38 offset:192
    v_pk_mul_f32 v[80:81], v[58:59], v[58:59] op_sel_hi:[0,1]
    v_pk_fma_f32 v[80:81], v[58:59], v[58:59], v[80:81] op_sel:[1,1,0] op_sel_hi:[1,0,1] neg_lo:[1,0,0]
    v_pk_mul_f32 v[84:85], v[80:81], v[68:69] op_sel_hi:[0,1]
    v_pk_fma_f32 v[84:85], v[80:81], v[68:69], v[84:85] op_sel:[1,1,0] op_sel_hi:[1,0,1] neg_lo:[1,0,0]
    v_cvt_pk_bf16_f32 v64, v80, v81
    v_pk_mul_f32 v[86:87], v[80:81], v[72:73] op_sel_hi:[0,1]
    v_pk_fma_f32 v[86:87], v[80:81], v[72:73], v[86:87] op_sel:[1,1,0] op_sel_hi:[1,0,1] neg_lo:[1,0,0]
    v_cvt_pk_bf16_f32 v65, v84, v85
    ds_write2_b32 v41, v64, v65 offset0:0 offset1:72
    v_pk_mul_f32 v[84:85], v[80:81], v[76:77] op_sel_hi:[0,1]
    v_pk_fma_f32 v[84:85], v[80:81], v[76:77], v[84:85] op_sel:[1,1,0] op_sel_hi:[1,0,1] neg_lo:[1,0,0]
    v_cvt_pk_bf16_f32 v66, v86, v87
    v_pk_mul_f32 v[82:83], v[80:81], v[58:59] op_sel_hi:[0,1]
    v_pk_fma_f32 v[82:83], v[80:81], v[58:59], v[82:83] op_sel:[1,1,0] op_sel_hi:[1,0,1] neg_lo:[1,0,0]
    v_cvt_pk_bf16_f32 v67, v84, v85
    ds_write2_b32 v41, v66, v67 offset0:144 offset1:216
    v_pk_mul_f32 v[86:87], v[82:83], v[68:69] op_sel_hi:[0,1]
    v_pk_fma_f32 v[86:87], v[82:83], v[68:69], v[86:87] op_sel:[1,1,0] op_sel_hi:[1,0,1] neg_lo:[1,0,0]
    v_cvt_pk_bf16_f32 v64, v82, v83
    v_pk_mul_f32 v[84:85], v[82:83], v[72:73] op_sel_hi:[0,1]
    v_pk_fma_f32 v[84:85], v[82:83], v[72:73], v[84:85] op_sel:[1,1,0] op_sel_hi:[1,0,1] neg_lo:[1,0,0]
    v_cvt_pk_bf16_f32 v65, v86, v87
    ds_write2_b32 v42, v64, v65 offset0:0 offset1:72
    v_pk_mul_f32 v[86:87], v[82:83], v[76:77] op_sel_hi:[0,1]
    v_pk_fma_f32 v[86:87], v[82:83], v[76:77], v[86:87] op_sel:[1,1,0] op_sel_hi:[1,0,1] neg_lo:[1,0,0]
    v_cvt_pk_bf16_f32 v66, v84, v85
    v_pk_mul_f32 v[80:81], v[82:83], v[58:59] op_sel_hi:[0,1]
    v_pk_fma_f32 v[80:81], v[82:83], v[58:59], v[80:81] op_sel:[1,1,0] op_sel_hi:[1,0,1] neg_lo:[1,0,0]
    v_cvt_pk_bf16_f32 v67, v86, v87
    ds_write2_b32 v42, v66, v67 offset0:144 offset1:216
    v_pk_mul_f32 v[84:85], v[80:81], v[72:73] op_sel_hi:[0,1]
    v_pk_fma_f32 v[84:85], v[80:81], v[72:73], v[84:85] op_sel:[1,1,0] op_sel_hi:[1,0,1] neg_lo:[1,0,0]
    v_cvt_pk_bf16_f32 v64, v80, v81
    v_pk_mul_f32 v[82:83], v[80:81], v[58:59] op_sel_hi:[0,1]
    v_pk_fma_f32 v[82:83], v[80:81], v[58:59], v[82:83] op_sel:[1,1,0] op_sel_hi:[1,0,1] neg_lo:[1,0,0]
    v_cvt_pk_bf16_f32 v65, v84, v85
    ds_write2_b32 v43, v64, v65 offset0:0 offset1:72
    v_pk_mul_f32 v[86:87], v[82:83], v[72:73] op_sel_hi:[0,1]
    v_pk_fma_f32 v[86:87], v[82:83], v[72:73], v[86:87] op_sel:[1,1,0] op_sel_hi:[1,0,1] neg_lo:[1,0,0]
    v_cvt_pk_bf16_f32 v66, v82, v83
    v_pk_mul_f32 v[80:81], v[82:83], v[58:59] op_sel_hi:[0,1]
    v_pk_fma_f32 v[80:81], v[82:83], v[58:59], v[80:81] op_sel:[1,1,0] op_sel_hi:[1,0,1] neg_lo:[1,0,0]
    v_cvt_pk_bf16_f32 v67, v86, v87
    ds_write2_b32 v43, v66, v67 offset0:144 offset1:216
    v_pk_mul_f32 v[84:85], v[80:81], v[72:73] op_sel_hi:[0,1]
    v_pk_fma_f32 v[84:85], v[80:81], v[72:73], v[84:85] op_sel:[1,1,0] op_sel_hi:[1,0,1] neg_lo:[1,0,0]
    v_cvt_pk_bf16_f32 v64, v80, v81
    v_pk_mul_f32 v[82:83], v[80:81], v[58:59] op_sel_hi:[0,1]
    v_pk_fma_f32 v[82:83], v[80:81], v[58:59], v[82:83] op_sel:[1,1,0] op_sel_hi:[1,0,1] neg_lo:[1,0,0]
    v_cvt_pk_bf16_f32 v65, v84, v85
    ds_write2_b32 v44, v64, v65 offset0:0 offset1:72
    v_pk_mul_f32 v[86:87], v[82:83], v[72:73] op_sel_hi:[0,1]
    v_pk_fma_f32 v[86:87], v[82:83], v[72:73], v[86:87] op_sel:[1,1,0] op_sel_hi:[1,0,1] neg_lo:[1,0,0]
    v_cvt_pk_bf16_f32 v66, v82, v83
    v_cvt_pk_bf16_f32 v67, v86, v87
    ds_write2_b32 v44, v66, v67 offset0:144 offset1:216
    s_waitcnt lgkmcnt(8)
    v_mfma_f32_16x16x32_bf16 v[120:123], v[88:91], v[104:107], 0
    v_mfma_f32_16x16x32_bf16 v[120:123], v[92:95], v[108:111], v[120:123]
    v_mfma_f32_16x16x32_bf16 v[120:123], v[96:99], v[112:115], v[120:123]
    v_mfma_f32_16x16x32_bf16 v[120:123], v[100:103], v[116:119], v[120:123]
    ds_read_b128 v[104:107], v38 offset:0
    ds_read_b128 v[108:111], v38 offset:64
    ds_read_b128 v[112:115], v38 offset:128
    ds_read_b128 v[116:119], v38 offset:192
    v_pk_mul_f32 v[80:81], v[82:83], v[58:59] op_sel_hi:[0,1]
    v_pk_fma_f32 v[80:81], v[82:83], v[58:59], v[80:81] op_sel:[1,1,0] op_sel_hi:[1,0,1] neg_lo:[1,0,0]
    v_pk_mul_f32 v[82:83], v[80:81], v[58:59] op_sel_hi:[0,1]
    v_pk_fma_f32 v[82:83], v[80:81], v[58:59], v[82:83] op_sel:[1,1,0] op_sel_hi:[1,0,1] neg_lo:[1,0,0]
    v_cvt_pk_bf16_f32 v64, v80, v81
    v_pk_mul_f32 v[80:81], v[82:83], v[58:59] op_sel_hi:[0,1]
    v_pk_fma_f32 v[80:81], v[82:83], v[58:59], v[80:81] op_sel:[1,1,0] op_sel_hi:[1,0,1] neg_lo:[1,0,0]
    v_cvt_pk_bf16_f32 v65, v82, v83
    ds_write2_b32 v41, v64, v65 offset0:0 offset1:72
    v_pk_mul_f32 v[82:83], v[80:81], v[58:59] op_sel_hi:[0,1]
    v_pk_fma_f32 v[82:83], v[80:81], v[58:59], v[82:83] op_sel:[1,1,0] op_sel_hi:[1,0,1] neg_lo:[1,0,0]
    v_cvt_pk_bf16_f32 v66, v80, v81
    v_pk_mul_f32 v[80:81], v[82:83], v[58:59] op_sel_hi:[0,1]
    v_pk_fma_f32 v[80:81], v[82:83], v[58:59], v[80:81] op_sel:[1,1,0] op_sel_hi:[1,0,1] neg_lo:[1,0,0]
    v_cvt_pk_bf16_f32 v67, v82, v83
    ds_write2_b32 v41, v66, v67 offset0:144 offset1:216
    v_pk_mul_f32 v[82:83], v[80:81], v[58:59] op_sel_hi:[0,1]
    v_pk_fma_f32 v[82:83], v[80:81], v[58:59], v[82:83] op_sel:[1,1,0] op_sel_hi:[1,0,1] neg_lo:[1,0,0]
    v_cvt_pk_bf16_f32 v64, v80, v81
    v_pk_mul_f32 v[80:81], v[82:83], v[58:59] op_sel_hi:[0,1]
    v_pk_fma_f32 v[80:81], v[82:83], v[58:59], v[80:81] op_sel:[1,1,0] op_sel_hi:[1,0,1] neg_lo:[1,0,0]
    v_cvt_pk_bf16_f32 v65, v82, v83
    ds_write2_b32 v42, v64, v65 offset0:0 offset1:72
    v_pk_mul_f32 v[82:83], v[80:81], v[58:59] op_sel_hi:[0,1]
    v_pk_fma_f32 v[82:83], v[80:81], v[58:59], v[82:83] op_sel:[1,1,0] op_sel_hi:[1,0,1] neg_lo:[1,0,0]
    v_cvt_pk_bf16_f32 v66, v80, v81
    v_pk_mul_f32 v[80:81], v[82:83], v[58:59] op_sel_hi:[0,1]
    v_pk_fma_f32 v[80:81], v[82:83], v[58:59], v[80:81] op_sel:[1,1,0] op_sel_hi:[1,0,1] neg_lo:[1,0,0]
    v_cvt_pk_bf16_f32 v67, v82, v83
    ds_write2_b32 v42, v66, v67 offset0:144 offset1:216
    v_cvt_pk_bf16_f32 v64, v80, v81
    ds_write_b32 v43, v64 offset:0
    s_waitcnt lgkmcnt(5)
    v_mfma_f32_16x16x32_bf16 v[124:127], v[88:91], v[104:107], 0
    v_mfma_f32_16x16x32_bf16 v[124:127], v[92:95], v[108:111], v[124:127]
    v_mfma_f32_16x16x32_bf16 v[124:127], v[96:99], v[112:115], v[124:127]
    v_mfma_f32_16x16x32_bf16 v[124:127], v[100:103], v[116:119], v[124:127]
    ds_read_b128 v[104:107], v38 offset:0
    ds_read_b128 v[108:111], v38 offset:64
    ds_read_b128 v[112:115], v38 offset:128
    ds_read_b128 v[116:119], v38 offset:192
    s_waitcnt lgkmcnt(0)
    v_mfma_f32_16x16x32_bf16 v[128:131], v[88:91], v[104:107], 0
    v_mfma_f32_16x16x32_bf16 v[128:131], v[92:95], v[108:111], v[128:131]
    v_mfma_f32_16x16x32_bf16 v[128:131], v[96:99], v[112:115], v[128:131]
    v_mfma_f32_16x16x32_bf16 v[128:131], v[100:103], v[116:119], v[128:131]
    ds_write_b128 v39, v[120:123] offset:0
    ds_write_b128 v39, v[124:127] offset:1024
    s_nop 5
    ds_write_b128 v39, v[128:131] offset:2048
    s_setprio 1
    v_min_u32 v1, 2, v0
    v_lshlrev_b32 v1, 2, v1
    s_waitcnt lgkmcnt(0)
    s_barrier
    s_cmp_ge_u32 s2, 224
    s_cbranch_scc1 Lm_svc
    .p2align 3
    ds_read_b128 v[32:35], v5 offset:16384
    ds_read_b64_tr_b16 v[48:49], v7 offset:0
    ds_read_b64_tr_b16 v[50:51], v7 offset:1024
    ds_read_b128 v[36:39], v5 offset:18432
    ds_read_b128 v[40:43], v5 offset:20480
    ds_read_b128 v[44:47], v5 offset:22528
    ds_read_b64_tr_b16 v[52:53], v7 offset:16384
    ds_read_b64_tr_b16 v[54:55], v7 offset:17408
    ds_read_b64_tr_b16 v[56:57], v8 offset:0
    ds_read_b64_tr_b16 v[58:59], v8 offset:1024
    ds_read_b64_tr_b16 v[60:61], v8 offset:16384
    ds_read_b64_tr_b16 v[62:63], v8 offset:17408
    ds_read_b64_tr_b16 v[64:65], v9 offset:0
    ds_read_b64_tr_b16 v[66:67], v9 offset:1024
    ds_read_b64_tr_b16 v[68:69], v9 offset:16384
    ds_read_b64_tr_b16 v[70:71], v9 offset:17408
    ds_read_b64_tr_b16 v[72:73], v10 offset:0
    ds_read_b64_tr_b16 v[74:75], v10 offset:1024
    ds_read_b64_tr_b16 v[76:77], v10 offset:16384
    ds_read_b64_tr_b16 v[78:79], v10 offset:17408
    s_waitcnt lgkmcnt(12)
    v_mfma_f32_16x16x32_bf16 v[128:131], v[48:51], v[32:35], 0
    ds_read_b128 v[80:83], v6 offset:16384
    v_mfma_f32_16x16x32_bf16 v[132:135], v[48:51], v[36:39], 0
    ds_read_b64_tr_b16 v[96:97], v7 offset:8192
    v_mfma_f32_16x16x32_bf16 v[136:139], v[48:51], v[40:43], 0
    ds_read_b64_tr_b16 v[98:99], v7 offset:9216
    v_mfma_f32_16x16x32_bf16 v[140:143], v[48:51], v[44:47], 0
    ds_read_b128 v[84:87], v6 offset:18432
    v_mfma_f32_16x16x32_bf16 v[144:147], v[52:55], v[32:35], 0
    ds_read_b128 v[88:91], v6 offset:20480
    v_mfma_f32_16x16x32_bf16 v[148:151], v[52:55], v[36:39], 0
    ds_read_b128 v[92:95], v6 offset:22528
    v_mfma_f32_16x16x32_bf16 v[152:155], v[52:55], v[40:43], 0
    ds_read_b64_tr_b16 v[100:101], v7 offset:24576
    v_mfma_f32_16x16x32_bf16 v[156:159], v[52:55], v[44:47], 0
    ds_read_b64_tr_b16 v[102:103], v7 offset:25600
    s_waitcnt lgkmcnt(15)
    v_mfma_f32_16x16x32_bf16 v[160:163], v[56:59], v[32:35], 0
    ds_read_b64_tr_b16 v[104:105], v8 offset:8192
    v_mfma_f32_16x16x32_bf16 v[164:167], v[56:59], v[36:39], 0
    ds_read_b64_tr_b16 v[106:107], v8 offset:9216
    v_mfma_f32_16x16x32_bf16 v[168:171], v[56:59], v[40:43], 0
    ds_read_b64_tr_b16 v[108:109], v8 offset:24576
    v_mfma_f32_16x16x32_bf16 v[172:175], v[56:59], v[44:47], 0
    ds_read_b64_tr_b16 v[110:111], v8 offset:25600
    v_mfma_f32_16x16x32_bf16 v[176:179], v[60:63], v[32:35], 0
    ds_read_b64_tr_b16 v[112:113], v9 offset:8192
    v_mfma_f32_16x16x32_bf16 v[180:183], v[60:63], v[36:39], 0
    ds_read_b64_tr_b16 v[114:115], v9 offset:9216
    v_mfma_f32_16x16x32_bf16 v[184:187], v[60:63], v[40:43], 0
    ds_read_b64_tr_b16 v[116:117], v9 offset:24576
    v_mfma_f32_16x16x32_bf16 v[188:191], v[60:63], v[44:47], 0
    ds_read_b64_tr_b16 v[118:119], v9 offset:25600
    s_waitcnt lgkmcnt(15)
    v_mfma_f32_16x16x32_bf16 v[192:195], v[64:67], v[32:35], 0
    ds_read_b64_tr_b16 v[120:121], v10 offset:8192
    v_mfma_f32_16x16x32_bf16 v[196:199], v[64:67], v[36:39], 0
    ds_read_b64_tr_b16 v[122:123], v10 offset:9216
    v_mfma_f32_16x16x32_bf16 v[200:203], v[64:67], v[40:43], 0
    ds_read_b64_tr_b16 v[124:125], v10 offset:24576
    v_mfma_f32_16x16x32_bf16 v[204:207], v[64:67], v[44:47], 0
    ds_read_b64_tr_b16 v[126:127], v10 offset:25600
    v_mfma_f32_16x16x32_bf16 v[208:211], v[68:71], v[32:35], 0
    v_mfma_f32_16x16x32_bf16 v[212:215], v[68:71], v[36:39], 0
    v_mfma_f32_16x16x32_bf16 v[216:219], v[68:71], v[40:43], 0
    v_mfma_f32_16x16x32_bf16 v[220:223], v[68:71], v[44:47], 0
    v_mfma_f32_16x16x32_bf16 v[224:227], v[72:75], v[32:35], 0
    v_mfma_f32_16x16x32_bf16 v[228:231], v[72:75], v[36:39], 0
    v_mfma_f32_16x16x32_bf16 v[232:235], v[72:75], v[40:43], 0
    v_mfma_f32_16x16x32_bf16 v[236:239], v[72:75], v[44:47], 0
    v_mfma_f32_16x16x32_bf16 v[240:243], v[76:79], v[32:35], 0
    v_mfma_f32_16x16x32_bf16 v[244:247], v[76:79], v[36:39], 0
    v_mfma_f32_16x16x32_bf16 v[248:251], v[76:79], v[40:43], 0
    v_mfma_f32_16x16x32_bf16 v[252:255], v[76:79], v[44:47], 0
    s_waitcnt lgkmcnt(0)
    v_mfma_f32_16x16x32_bf16 v[128:131], v[96:99], v[80:83], v[128:131]
    v_mfma_f32_16x16x32_bf16 v[132:135], v[96:99], v[84:87], v[132:135]
    s_barrier
    ds_read_b128 v[32:35], v5 offset:32768
    v_mfma_f32_16x16x32_bf16 v[136:139], v[96:99], v[88:91], v[136:139]
    ds_read_b64_tr_b16 v[48:49], v7 offset:32768
    v_mfma_f32_16x16x32_bf16 v[140:143], v[96:99], v[92:95], v[140:143]
    ds_read_b64_tr_b16 v[50:51], v7 offset:33792
    v_mfma_f32_16x16x32_bf16 v[144:147], v[100:103], v[80:83], v[144:147]
    ds_read_b128 v[36:39], v5 offset:34816
    v_mfma_f32_16x16x32_bf16 v[148:151], v[100:103], v[84:87], v[148:151]
    ds_read_b128 v[40:43], v5 offset:36864
    v_mfma_f32_16x16x32_bf16 v[152:155], v[100:103], v[88:91], v[152:155]
    ds_read_b128 v[44:47], v5 offset:38912
    v_mfma_f32_16x16x32_bf16 v[156:159], v[100:103], v[92:95], v[156:159]
    ds_read_b64_tr_b16 v[52:53], v7 offset:49152
    v_mfma_f32_16x16x32_bf16 v[160:163], v[104:107], v[80:83], v[160:163]
    ds_read_b64_tr_b16 v[54:55], v7 offset:50176
    v_mfma_f32_16x16x32_bf16 v[164:167], v[104:107], v[84:87], v[164:167]
    ds_read_b64_tr_b16 v[56:57], v8 offset:32768
    v_mfma_f32_16x16x32_bf16 v[168:171], v[104:107], v[88:91], v[168:171]
    ds_read_b64_tr_b16 v[58:59], v8 offset:33792
    v_mfma_f32_16x16x32_bf16 v[172:175], v[104:107], v[92:95], v[172:175]
    ds_read_b64_tr_b16 v[60:61], v8 offset:49152
    v_mfma_f32_16x16x32_bf16 v[176:179], v[108:111], v[80:83], v[176:179]
    ds_read_b64_tr_b16 v[62:63], v8 offset:50176
    v_mfma_f32_16x16x32_bf16 v[180:183], v[108:111], v[84:87], v[180:183]
    ds_read_b64_tr_b16 v[64:65], v9 offset:32768
    v_mfma_f32_16x16x32_bf16 v[184:187], v[108:111], v[88:91], v[184:187]
    ds_read_b64_tr_b16 v[66:67], v9 offset:33792
    v_mfma_f32_16x16x32_bf16 v[188:191], v[108:111], v[92:95], v[188:191]
    ds_read_b64_tr_b16 v[68:69], v9 offset:49152
    v_mfma_f32_16x16x32_bf16 v[192:195], v[112:115], v[80:83], v[192:195]
    ds_read_b64_tr_b16 v[70:71], v9 offset:50176
    v_mfma_f32_16x16x32_bf16 v[196:199], v[112:115], v[84:87], v[196:199]
    ds_read_b64_tr_b16 v[72:73], v10 offset:32768
    v_mfma_f32_16x16x32_bf16 v[200:203], v[112:115], v[88:91], v[200:203]
    ds_read_b64_tr_b16 v[74:75], v10 offset:33792
    v_mfma_f32_16x16x32_bf16 v[204:207], v[112:115], v[92:95], v[204:207]
    ds_read_b64_tr_b16 v[76:77], v10 offset:49152
    v_mfma_f32_16x16x32_bf16 v[208:211], v[116:119], v[80:83], v[208:211]
    ds_read_b64_tr_b16 v[78:79], v10 offset:50176
    v_mfma_f32_16x16x32_bf16 v[212:215], v[116:119], v[84:87], v[212:215]
    v_mfma_f32_16x16x32_bf16 v[216:219], v[116:119], v[88:91], v[216:219]
    v_mfma_f32_16x16x32_bf16 v[220:223], v[116:119], v[92:95], v[220:223]
    v_mfma_f32_16x16x32_bf16 v[224:227], v[120:123], v[80:83], v[224:227]
    v_mfma_f32_16x16x32_bf16 v[228:231], v[120:123], v[84:87], v[228:231]
    v_mfma_f32_16x16x32_bf16 v[232:235], v[120:123], v[88:91], v[232:235]
    v_mfma_f32_16x16x32_bf16 v[236:239], v[120:123], v[92:95], v[236:239]
    v_mfma_f32_16x16x32_bf16 v[240:243], v[124:127], v[80:83], v[240:243]
    v_mfma_f32_16x16x32_bf16 v[244:247], v[124:127], v[84:87], v[244:247]
    v_mfma_f32_16x16x32_bf16 v[248:251], v[124:127], v[88:91], v[248:251]
    v_mfma_f32_16x16x32_bf16 v[252:255], v[124:127], v[92:95], v[252:255]
    s_waitcnt lgkmcnt(12)
    v_mfma_f32_16x16x32_bf16 v[128:131], v[48:51], v[32:35], v[128:131]
    ds_read_b128 v[80:83], v6 offset:32768
    v_mfma_f32_16x16x32_bf16 v[132:135], v[48:51], v[36:39], v[132:135]
    ds_read_b64_tr_b16 v[96:97], v7 offset:40960
    v_mfma_f32_16x16x32_bf16 v[136:139], v[48:51], v[40:43], v[136:139]
    ds_read_b64_tr_b16 v[98:99], v7 offset:41984
    v_mfma_f32_16x16x32_bf16 v[140:143], v[48:51], v[44:47], v[140:143]
    ds_read_b128 v[84:87], v6 offset:34816
    v_mfma_f32_16x16x32_bf16 v[144:147], v[52:55], v[32:35], v[144:147]
    ds_read_b128 v[88:91], v6 offset:36864
    v_mfma_f32_16x16x32_bf16 v[148:151], v[52:55], v[36:39], v[148:151]
    ds_read_b128 v[92:95], v6 offset:38912
    v_mfma_f32_16x16x32_bf16 v[152:155], v[52:55], v[40:43], v[152:155]
    ds_read_b64_tr_b16 v[100:101], v7 offset:57344
    v_mfma_f32_16x16x32_bf16 v[156:159], v[52:55], v[44:47], v[156:159]
    ds_read_b64_tr_b16 v[102:103], v7 offset:58368
    s_waitcnt lgkmcnt(15)
    v_mfma_f32_16x16x32_bf16 v[160:163], v[56:59], v[32:35], v[160:163]
    ds_read_b64_tr_b16 v[104:105], v8 offset:40960
    v_mfma_f32_16x16x32_bf16 v[164:167], v[56:59], v[36:39], v[164:167]
    ds_read_b64_tr_b16 v[106:107], v8 offset:41984
    v_mfma_f32_16x16x32_bf16 v[168:171], v[56:59], v[40:43], v[168:171]
    ds_read_b64_tr_b16 v[108:109], v8 offset:57344
    v_mfma_f32_16x16x32_bf16 v[172:175], v[56:59], v[44:47], v[172:175]
    ds_read_b64_tr_b16 v[110:111], v8 offset:58368
    v_mfma_f32_16x16x32_bf16 v[176:179], v[60:63], v[32:35], v[176:179]
    ds_read_b64_tr_b16 v[112:113], v9 offset:40960
    v_mfma_f32_16x16x32_bf16 v[180:183], v[60:63], v[36:39], v[180:183]
    ds_read_b64_tr_b16 v[114:115], v9 offset:41984
    v_mfma_f32_16x16x32_bf16 v[184:187], v[60:63], v[40:43], v[184:187]
    ds_read_b64_tr_b16 v[116:117], v9 offset:57344
    v_mfma_f32_16x16x32_bf16 v[188:191], v[60:63], v[44:47], v[188:191]
    ds_read_b64_tr_b16 v[118:119], v9 offset:58368
    s_waitcnt lgkmcnt(15)
    v_mfma_f32_16x16x32_bf16 v[192:195], v[64:67], v[32:35], v[192:195]
    ds_read_b64_tr_b16 v[120:121], v10 offset:40960
    v_mfma_f32_16x16x32_bf16 v[196:199], v[64:67], v[36:39], v[196:199]
    ds_read_b64_tr_b16 v[122:123], v10 offset:41984
    v_mfma_f32_16x16x32_bf16 v[200:203], v[64:67], v[40:43], v[200:203]
    ds_read_b64_tr_b16 v[124:125], v10 offset:57344
    v_mfma_f32_16x16x32_bf16 v[204:207], v[64:67], v[44:47], v[204:207]
    ds_read_b64_tr_b16 v[126:127], v10 offset:58368
    v_mfma_f32_16x16x32_bf16 v[208:211], v[68:71], v[32:35], v[208:211]
    v_mfma_f32_16x16x32_bf16 v[212:215], v[68:71], v[36:39], v[212:215]
    v_mfma_f32_16x16x32_bf16 v[216:219], v[68:71], v[40:43], v[216:219]
    v_mfma_f32_16x16x32_bf16 v[220:223], v[68:71], v[44:47], v[220:223]
    v_mfma_f32_16x16x32_bf16 v[224:227], v[72:75], v[32:35], v[224:227]
    v_mfma_f32_16x16x32_bf16 v[228:231], v[72:75], v[36:39], v[228:231]
    v_mfma_f32_16x16x32_bf16 v[232:235], v[72:75], v[40:43], v[232:235]
    v_mfma_f32_16x16x32_bf16 v[236:239], v[72:75], v[44:47], v[236:239]
    v_mfma_f32_16x16x32_bf16 v[240:243], v[76:79], v[32:35], v[240:243]
    v_mfma_f32_16x16x32_bf16 v[244:247], v[76:79], v[36:39], v[244:247]
    v_mfma_f32_16x16x32_bf16 v[248:251], v[76:79], v[40:43], v[248:251]
    v_mfma_f32_16x16x32_bf16 v[252:255], v[76:79], v[44:47], v[252:255]
    s_waitcnt lgkmcnt(0)
    v_mfma_f32_16x16x32_bf16 v[128:131], v[96:99], v[80:83], v[128:131]
    v_mfma_f32_16x16x32_bf16 v[132:135], v[96:99], v[84:87], v[132:135]
    s_barrier
    ds_read_b128 v[32:35], v5 offset:0
    v_mfma_f32_16x16x32_bf16 v[136:139], v[96:99], v[88:91], v[136:139]
    ds_read_b64_tr_b16 v[48:49], v11 offset:0
    v_mfma_f32_16x16x32_bf16 v[140:143], v[96:99], v[92:95], v[140:143]
    ds_read_b64_tr_b16 v[50:51], v11 offset:1024
    v_mfma_f32_16x16x32_bf16 v[144:147], v[100:103], v[80:83], v[144:147]
    ds_read_b128 v[36:39], v5 offset:2048
    v_mfma_f32_16x16x32_bf16 v[148:151], v[100:103], v[84:87], v[148:151]
    ds_read_b128 v[40:43], v5 offset:4096
    v_mfma_f32_16x16x32_bf16 v[152:155], v[100:103], v[88:91], v[152:155]
    ds_read_b128 v[44:47], v5 offset:6144
    v_mfma_f32_16x16x32_bf16 v[156:159], v[100:103], v[92:95], v[156:159]
    ds_read_b64_tr_b16 v[52:53], v11 offset:16384
    v_mfma_f32_16x16x32_bf16 v[160:163], v[104:107], v[80:83], v[160:163]
    ds_read_b64_tr_b16 v[54:55], v11 offset:17408
    v_mfma_f32_16x16x32_bf16 v[164:167], v[104:107], v[84:87], v[164:167]
    ds_read_b64_tr_b16 v[56:57], v12 offset:0
    v_mfma_f32_16x16x32_bf16 v[168:171], v[104:107], v[88:91], v[168:171]
    ds_read_b64_tr_b16 v[58:59], v12 offset:1024
    v_mfma_f32_16x16x32_bf16 v[172:175], v[104:107], v[92:95], v[172:175]
    ds_read_b64_tr_b16 v[60:61], v12 offset:16384
    v_mfma_f32_16x16x32_bf16 v[176:179], v[108:111], v[80:83], v[176:179]
    ds_read_b64_tr_b16 v[62:63], v12 offset:17408
    v_mfma_f32_16x16x32_bf16 v[180:183], v[108:111], v[84:87], v[180:183]
    ds_read_b64_tr_b16 v[64:65], v13 offset:0
    v_mfma_f32_16x16x32_bf16 v[184:187], v[108:111], v[88:91], v[184:187]
    ds_read_b64_tr_b16 v[66:67], v13 offset:1024
    v_mfma_f32_16x16x32_bf16 v[188:191], v[108:111], v[92:95], v[188:191]
    ds_read_b64_tr_b16 v[68:69], v13 offset:16384
    v_mfma_f32_16x16x32_bf16 v[192:195], v[112:115], v[80:83], v[192:195]
    ds_read_b64_tr_b16 v[70:71], v13 offset:17408
    v_mfma_f32_16x16x32_bf16 v[196:199], v[112:115], v[84:87], v[196:199]
    ds_read_b64_tr_b16 v[72:73], v14 offset:0
    v_mfma_f32_16x16x32_bf16 v[200:203], v[112:115], v[88:91], v[200:203]
    ds_read_b64_tr_b16 v[74:75], v14 offset:1024
    v_mfma_f32_16x16x32_bf16 v[204:207], v[112:115], v[92:95], v[204:207]
    ds_read_b64_tr_b16 v[76:77], v14 offset:16384
    v_mfma_f32_16x16x32_bf16 v[208:211], v[116:119], v[80:83], v[208:211]
    ds_read_b64_tr_b16 v[78:79], v14 offset:17408
    v_mfma_f32_16x16x32_bf16 v[212:215], v[116:119], v[84:87], v[212:215]
    v_mfma_f32_16x16x32_bf16 v[216:219], v[116:119], v[88:91], v[216:219]
    v_mfma_f32_16x16x32_bf16 v[220:223], v[116:119], v[92:95], v[220:223]
    v_mfma_f32_16x16x32_bf16 v[224:227], v[120:123], v[80:83], v[224:227]
    v_mfma_f32_16x16x32_bf16 v[228:231], v[120:123], v[84:87], v[228:231]
    v_mfma_f32_16x16x32_bf16 v[232:235], v[120:123], v[88:91], v[232:235]
    v_mfma_f32_16x16x32_bf16 v[236:239], v[120:123], v[92:95], v[236:239]
    v_mfma_f32_16x16x32_bf16 v[240:243], v[124:127], v[80:83], v[240:243]
    v_mfma_f32_16x16x32_bf16 v[244:247], v[124:127], v[84:87], v[244:247]
    v_mfma_f32_16x16x32_bf16 v[248:251], v[124:127], v[88:91], v[248:251]
    v_mfma_f32_16x16x32_bf16 v[252:255], v[124:127], v[92:95], v[252:255]
    s_waitcnt lgkmcnt(12)
    v_mfma_f32_16x16x32_bf16 v[128:131], v[48:51], v[32:35], v[128:131]
    ds_read_b128 v[80:83], v6 offset:0
    v_mfma_f32_16x16x32_bf16 v[132:135], v[48:51], v[36:39], v[132:135]
    ds_read_b64_tr_b16 v[96:97], v11 offset:8192
    v_mfma_f32_16x16x32_bf16 v[136:139], v[48:51], v[40:43], v[136:139]
    ds_read_b64_tr_b16 v[98:99], v11 offset:9216
    v_mfma_f32_16x16x32_bf16 v[140:143], v[48:51], v[44:47], v[140:143]
    ds_read_b128 v[84:87], v6 offset:2048
    v_mfma_f32_16x16x32_bf16 v[144:147], v[52:55], v[32:35], v[144:147]
    ds_read_b128 v[88:91], v6 offset:4096
    v_mfma_f32_16x16x32_bf16 v[148:151], v[52:55], v[36:39], v[148:151]
    ds_read_b128 v[92:95], v6 offset:6144
    v_mfma_f32_16x16x32_bf16 v[152:155], v[52:55], v[40:43], v[152:155]
    ds_read_b64_tr_b16 v[100:101], v11 offset:24576
    v_mfma_f32_16x16x32_bf16 v[156:159], v[52:55], v[44:47], v[156:159]
    ds_read_b64_tr_b16 v[102:103], v11 offset:25600
    s_waitcnt lgkmcnt(15)
    v_mfma_f32_16x16x32_bf16 v[160:163], v[56:59], v[32:35], v[160:163]
    ds_read_b64_tr_b16 v[104:105], v12 offset:8192
    v_mfma_f32_16x16x32_bf16 v[164:167], v[56:59], v[36:39], v[164:167]
    ds_read_b64_tr_b16 v[106:107], v12 offset:9216
    v_mfma_f32_16x16x32_bf16 v[168:171], v[56:59], v[40:43], v[168:171]
    ds_read_b64_tr_b16 v[108:109], v12 offset:24576
    v_mfma_f32_16x16x32_bf16 v[172:175], v[56:59], v[44:47], v[172:175]
    ds_read_b64_tr_b16 v[110:111], v12 offset:25600
    v_mfma_f32_16x16x32_bf16 v[176:179], v[60:63], v[32:35], v[176:179]
    ds_read_b64_tr_b16 v[112:113], v13 offset:8192
    v_mfma_f32_16x16x32_bf16 v[180:183], v[60:63], v[36:39], v[180:183]
    ds_read_b64_tr_b16 v[114:115], v13 offset:9216
    v_mfma_f32_16x16x32_bf16 v[184:187], v[60:63], v[40:43], v[184:187]
    ds_read_b64_tr_b16 v[116:117], v13 offset:24576
    v_mfma_f32_16x16x32_bf16 v[188:191], v[60:63], v[44:47], v[188:191]
    ds_read_b64_tr_b16 v[118:119], v13 offset:25600
    s_waitcnt lgkmcnt(15)
    v_mfma_f32_16x16x32_bf16 v[192:195], v[64:67], v[32:35], v[192:195]
    ds_read_b64_tr_b16 v[120:121], v14 offset:8192
    v_mfma_f32_16x16x32_bf16 v[196:199], v[64:67], v[36:39], v[196:199]
    ds_read_b64_tr_b16 v[122:123], v14 offset:9216
    v_mfma_f32_16x16x32_bf16 v[200:203], v[64:67], v[40:43], v[200:203]
    ds_read_b64_tr_b16 v[124:125], v14 offset:24576
    v_mfma_f32_16x16x32_bf16 v[204:207], v[64:67], v[44:47], v[204:207]
    ds_read_b64_tr_b16 v[126:127], v14 offset:25600
    v_mfma_f32_16x16x32_bf16 v[208:211], v[68:71], v[32:35], v[208:211]
    v_mfma_f32_16x16x32_bf16 v[212:215], v[68:71], v[36:39], v[212:215]
    v_mfma_f32_16x16x32_bf16 v[216:219], v[68:71], v[40:43], v[216:219]
    v_mfma_f32_16x16x32_bf16 v[220:223], v[68:71], v[44:47], v[220:223]
    v_mfma_f32_16x16x32_bf16 v[224:227], v[72:75], v[32:35], v[224:227]
    v_mfma_f32_16x16x32_bf16 v[228:231], v[72:75], v[36:39], v[228:231]
    v_mfma_f32_16x16x32_bf16 v[232:235], v[72:75], v[40:43], v[232:235]
    v_mfma_f32_16x16x32_bf16 v[236:239], v[72:75], v[44:47], v[236:239]
    v_mfma_f32_16x16x32_bf16 v[240:243], v[76:79], v[32:35], v[240:243]
    v_mfma_f32_16x16x32_bf16 v[244:247], v[76:79], v[36:39], v[244:247]
    v_mfma_f32_16x16x32_bf16 v[248:251], v[76:79], v[40:43], v[248:251]
    v_mfma_f32_16x16x32_bf16 v[252:255], v[76:79], v[44:47], v[252:255]
    s_waitcnt lgkmcnt(0)
    v_mfma_f32_16x16x32_bf16 v[128:131], v[96:99], v[80:83], v[128:131]
    v_mfma_f32_16x16x32_bf16 v[132:135], v[96:99], v[84:87], v[132:135]
    s_barrier
    ds_read_b128 v[32:35], v5 offset:16384
    v_mfma_f32_16x16x32_bf16 v[136:139], v[96:99], v[88:91], v[136:139]
    ds_read_b64_tr_b16 v[48:49], v7 offset:0
    v_mfma_f32_16x16x32_bf16 v[140:143], v[96:99], v[92:95], v[140:143]
    ds_read_b64_tr_b16 v[50:51], v7 offset:1024
    v_mfma_f32_16x16x32_bf16 v[144:147], v[100:103], v[80:83], v[144:147]
    ds_read_b128 v[36:39], v5 offset:18432
    v_mfma_f32_16x16x32_bf16 v[148:151], v[100:103], v[84:87], v[148:151]
    ds_read_b128 v[40:43], v5 offset:20480
    v_mfma_f32_16x16x32_bf16 v[152:155], v[100:103], v[88:91], v[152:155]
    ds_read_b128 v[44:47], v5 offset:22528
    v_mfma_f32_16x16x32_bf16 v[156:159], v[100:103], v[92:95], v[156:159]
    ds_read_b64_tr_b16 v[52:53], v7 offset:16384
    v_mfma_f32_16x16x32_bf16 v[160:163], v[104:107], v[80:83], v[160:163]
    ds_read_b64_tr_b16 v[54:55], v7 offset:17408
    v_mfma_f32_16x16x32_bf16 v[164:167], v[104:107], v[84:87], v[164:167]
    ds_read_b64_tr_b16 v[56:57], v8 offset:0
    v_mfma_f32_16x16x32_bf16 v[168:171], v[104:107], v[88:91], v[168:171]
    ds_read_b64_tr_b16 v[58:59], v8 offset:1024
    v_mfma_f32_16x16x32_bf16 v[172:175], v[104:107], v[92:95], v[172:175]
    ds_read_b64_tr_b16 v[60:61], v8 offset:16384
    v_mfma_f32_16x16x32_bf16 v[176:179], v[108:111], v[80:83], v[176:179]
    ds_read_b64_tr_b16 v[62:63], v8 offset:17408
    v_mfma_f32_16x16x32_bf16 v[180:183], v[108:111], v[84:87], v[180:183]
    ds_read_b64_tr_b16 v[64:65], v9 offset:0
    v_mfma_f32_16x16x32_bf16 v[184:187], v[108:111], v[88:91], v[184:187]
    ds_read_b64_tr_b16 v[66:67], v9 offset:1024
    v_mfma_f32_16x16x32_bf16 v[188:191], v[108:111], v[92:95], v[188:191]
    ds_read_b64_tr_b16 v[68:69], v9 offset:16384
    v_mfma_f32_16x16x32_bf16 v[192:195], v[112:115], v[80:83], v[192:195]
    ds_read_b64_tr_b16 v[70:71], v9 offset:17408
    v_mfma_f32_16x16x32_bf16 v[196:199], v[112:115], v[84:87], v[196:199]
    ds_read_b64_tr_b16 v[72:73], v10 offset:0
    v_mfma_f32_16x16x32_bf16 v[200:203], v[112:115], v[88:91], v[200:203]
    ds_read_b64_tr_b16 v[74:75], v10 offset:1024
    v_mfma_f32_16x16x32_bf16 v[204:207], v[112:115], v[92:95], v[204:207]
    ds_read_b64_tr_b16 v[76:77], v10 offset:16384
    v_mfma_f32_16x16x32_bf16 v[208:211], v[116:119], v[80:83], v[208:211]
    ds_read_b64_tr_b16 v[78:79], v10 offset:17408
    v_mfma_f32_16x16x32_bf16 v[212:215], v[116:119], v[84:87], v[212:215]
    v_mfma_f32_16x16x32_bf16 v[216:219], v[116:119], v[88:91], v[216:219]
    v_mfma_f32_16x16x32_bf16 v[220:223], v[116:119], v[92:95], v[220:223]
    v_mfma_f32_16x16x32_bf16 v[224:227], v[120:123], v[80:83], v[224:227]
    v_mfma_f32_16x16x32_bf16 v[228:231], v[120:123], v[84:87], v[228:231]
    v_mfma_f32_16x16x32_bf16 v[232:235], v[120:123], v[88:91], v[232:235]
    v_mfma_f32_16x16x32_bf16 v[236:239], v[120:123], v[92:95], v[236:239]
    v_mfma_f32_16x16x32_bf16 v[240:243], v[124:127], v[80:83], v[240:243]
    v_mfma_f32_16x16x32_bf16 v[244:247], v[124:127], v[84:87], v[244:247]
    v_mfma_f32_16x16x32_bf16 v[248:251], v[124:127], v[88:91], v[248:251]
    v_mfma_f32_16x16x32_bf16 v[252:255], v[124:127], v[92:95], v[252:255]
    s_waitcnt lgkmcnt(12)
    v_mfma_f32_16x16x32_bf16 v[128:131], v[48:51], v[32:35], v[128:131]
    ds_read_b128 v[80:83], v6 offset:16384
    v_mfma_f32_16x16x32_bf16 v[132:135], v[48:51], v[36:39], v[132:135]
    ds_read_b64_tr_b16 v[96:97], v7 offset:8192
    v_mfma_f32_16x16x32_bf16 v[136:139], v[48:51], v[40:43], v[136:139]
    ds_read_b64_tr_b16 v[98:99], v7 offset:9216
    v_mfma_f32_16x16x32_bf16 v[140:143], v[48:51], v[44:47], v[140:143]
    ds_read_b128 v[84:87], v6 offset:18432
    v_mfma_f32_16x16x32_bf16 v[144:147], v[52:55], v[32:35], v[144:147]
    ds_read_b128 v[88:91], v6 offset:20480
    v_mfma_f32_16x16x32_bf16 v[148:151], v[52:55], v[36:39], v[148:151]
    ds_read_b128 v[92:95], v6 offset:22528
    v_mfma_f32_16x16x32_bf16 v[152:155], v[52:55], v[40:43], v[152:155]
    ds_read_b64_tr_b16 v[100:101], v7 offset:24576
    v_mfma_f32_16x16x32_bf16 v[156:159], v[52:55], v[44:47], v[156:159]
    ds_read_b64_tr_b16 v[102:103], v7 offset:25600
    s_waitcnt lgkmcnt(15)
    v_mfma_f32_16x16x32_bf16 v[160:163], v[56:59], v[32:35], v[160:163]
    ds_read_b64_tr_b16 v[104:105], v8 offset:8192
    v_mfma_f32_16x16x32_bf16 v[164:167], v[56:59], v[36:39], v[164:167]
    ds_read_b64_tr_b16 v[106:107], v8 offset:9216
    v_mfma_f32_16x16x32_bf16 v[168:171], v[56:59], v[40:43], v[168:171]
    ds_read_b64_tr_b16 v[108:109], v8 offset:24576
    v_mfma_f32_16x16x32_bf16 v[172:175], v[56:59], v[44:47], v[172:175]
    ds_read_b64_tr_b16 v[110:111], v8 offset:25600
    v_mfma_f32_16x16x32_bf16 v[176:179], v[60:63], v[32:35], v[176:179]
    ds_read_b64_tr_b16 v[112:113], v9 offset:8192
    v_mfma_f32_16x16x32_bf16 v[180:183], v[60:63], v[36:39], v[180:183]
    ds_read_b64_tr_b16 v[114:115], v9 offset:9216
    v_mfma_f32_16x16x32_bf16 v[184:187], v[60:63], v[40:43], v[184:187]
    ds_read_b64_tr_b16 v[116:117], v9 offset:24576
    v_mfma_f32_16x16x32_bf16 v[188:191], v[60:63], v[44:47], v[188:191]
    ds_read_b64_tr_b16 v[118:119], v9 offset:25600
    s_waitcnt lgkmcnt(15)
    v_mfma_f32_16x16x32_bf16 v[192:195], v[64:67], v[32:35], v[192:195]
    ds_read_b64_tr_b16 v[120:121], v10 offset:8192
    v_mfma_f32_16x16x32_bf16 v[196:199], v[64:67], v[36:39], v[196:199]
    ds_read_b64_tr_b16 v[122:123], v10 offset:9216
    v_mfma_f32_16x16x32_bf16 v[200:203], v[64:67], v[40:43], v[200:203]
    ds_read_b64_tr_b16 v[124:125], v10 offset:24576
    v_mfma_f32_16x16x32_bf16 v[204:207], v[64:67], v[44:47], v[204:207]
    ds_read_b64_tr_b16 v[126:127], v10 offset:25600
    v_mfma_f32_16x16x32_bf16 v[208:211], v[68:71], v[32:35], v[208:211]
    v_mfma_f32_16x16x32_bf16 v[212:215], v[68:71], v[36:39], v[212:215]
    v_mfma_f32_16x16x32_bf16 v[216:219], v[68:71], v[40:43], v[216:219]
    v_mfma_f32_16x16x32_bf16 v[220:223], v[68:71], v[44:47], v[220:223]
    v_mfma_f32_16x16x32_bf16 v[224:227], v[72:75], v[32:35], v[224:227]
    v_mfma_f32_16x16x32_bf16 v[228:231], v[72:75], v[36:39], v[228:231]
    v_mfma_f32_16x16x32_bf16 v[232:235], v[72:75], v[40:43], v[232:235]
    v_mfma_f32_16x16x32_bf16 v[236:239], v[72:75], v[44:47], v[236:239]
    v_mfma_f32_16x16x32_bf16 v[240:243], v[76:79], v[32:35], v[240:243]
    v_mfma_f32_16x16x32_bf16 v[244:247], v[76:79], v[36:39], v[244:247]
    v_mfma_f32_16x16x32_bf16 v[248:251], v[76:79], v[40:43], v[248:251]
    v_mfma_f32_16x16x32_bf16 v[252:255], v[76:79], v[44:47], v[252:255]
    s_waitcnt lgkmcnt(0)
    v_mfma_f32_16x16x32_bf16 v[128:131], v[96:99], v[80:83], v[128:131]
    v_mfma_f32_16x16x32_bf16 v[132:135], v[96:99], v[84:87], v[132:135]
    s_barrier
    ds_read_b128 v[32:35], v5 offset:32768
    v_mfma_f32_16x16x32_bf16 v[136:139], v[96:99], v[88:91], v[136:139]
    ds_read_b64_tr_b16 v[48:49], v7 offset:32768
    v_mfma_f32_16x16x32_bf16 v[140:143], v[96:99], v[92:95], v[140:143]
    ds_read_b64_tr_b16 v[50:51], v7 offset:33792
    v_mfma_f32_16x16x32_bf16 v[144:147], v[100:103], v[80:83], v[144:147]
    ds_read_b128 v[36:39], v5 offset:34816
    v_mfma_f32_16x16x32_bf16 v[148:151], v[100:103], v[84:87], v[148:151]
    ds_read_b128 v[40:43], v5 offset:36864
    v_mfma_f32_16x16x32_bf16 v[152:155], v[100:103], v[88:91], v[152:155]
    ds_read_b128 v[44:47], v5 offset:38912
    v_mfma_f32_16x16x32_bf16 v[156:159], v[100:103], v[92:95], v[156:159]
    ds_read_b64_tr_b16 v[52:53], v7 offset:49152
    v_mfma_f32_16x16x32_bf16 v[160:163], v[104:107], v[80:83], v[160:163]
    ds_read_b64_tr_b16 v[54:55], v7 offset:50176
    v_mfma_f32_16x16x32_bf16 v[164:167], v[104:107], v[84:87], v[164:167]
    ds_read_b64_tr_b16 v[56:57], v8 offset:32768
    v_mfma_f32_16x16x32_bf16 v[168:171], v[104:107], v[88:91], v[168:171]
    ds_read_b64_tr_b16 v[58:59], v8 offset:33792
    v_mfma_f32_16x16x32_bf16 v[172:175], v[104:107], v[92:95], v[172:175]
    ds_read_b64_tr_b16 v[60:61], v8 offset:49152
    v_mfma_f32_16x16x32_bf16 v[176:179], v[108:111], v[80:83], v[176:179]
    ds_read_b64_tr_b16 v[62:63], v8 offset:50176
    v_mfma_f32_16x16x32_bf16 v[180:183], v[108:111], v[84:87], v[180:183]
    ds_read_b64_tr_b16 v[64:65], v9 offset:32768
    v_mfma_f32_16x16x32_bf16 v[184:187], v[108:111], v[88:91], v[184:187]
    ds_read_b64_tr_b16 v[66:67], v9 offset:33792
    v_mfma_f32_16x16x32_bf16 v[188:191], v[108:111], v[92:95], v[188:191]
    ds_read_b64_tr_b16 v[68:69], v9 offset:49152
    v_mfma_f32_16x16x32_bf16 v[192:195], v[112:115], v[80:83], v[192:195]
    ds_read_b64_tr_b16 v[70:71], v9 offset:50176
    v_mfma_f32_16x16x32_bf16 v[196:199], v[112:115], v[84:87], v[196:199]
    ds_read_b64_tr_b16 v[72:73], v10 offset:32768
    v_mfma_f32_16x16x32_bf16 v[200:203], v[112:115], v[88:91], v[200:203]
    ds_read_b64_tr_b16 v[74:75], v10 offset:33792
    v_mfma_f32_16x16x32_bf16 v[204:207], v[112:115], v[92:95], v[204:207]
    ds_read_b64_tr_b16 v[76:77], v10 offset:49152
    v_mfma_f32_16x16x32_bf16 v[208:211], v[116:119], v[80:83], v[208:211]
    ds_read_b64_tr_b16 v[78:79], v10 offset:50176
    v_mfma_f32_16x16x32_bf16 v[212:215], v[116:119], v[84:87], v[212:215]
    v_mfma_f32_16x16x32_bf16 v[216:219], v[116:119], v[88:91], v[216:219]
    v_mfma_f32_16x16x32_bf16 v[220:223], v[116:119], v[92:95], v[220:223]
    v_mfma_f32_16x16x32_bf16 v[224:227], v[120:123], v[80:83], v[224:227]
    v_mfma_f32_16x16x32_bf16 v[228:231], v[120:123], v[84:87], v[228:231]
    v_mfma_f32_16x16x32_bf16 v[232:235], v[120:123], v[88:91], v[232:235]
    v_mfma_f32_16x16x32_bf16 v[236:239], v[120:123], v[92:95], v[236:239]
    v_mfma_f32_16x16x32_bf16 v[240:243], v[124:127], v[80:83], v[240:243]
    v_mfma_f32_16x16x32_bf16 v[244:247], v[124:127], v[84:87], v[244:247]
    v_mfma_f32_16x16x32_bf16 v[248:251], v[124:127], v[88:91], v[248:251]
    v_mfma_f32_16x16x32_bf16 v[252:255], v[124:127], v[92:95], v[252:255]
    s_waitcnt lgkmcnt(12)
    v_mfma_f32_16x16x32_bf16 v[128:131], v[48:51], v[32:35], v[128:131]
    ds_read_b128 v[80:83], v6 offset:32768
    v_mfma_f32_16x16x32_bf16 v[132:135], v[48:51], v[36:39], v[132:135]
    ds_read_b64_tr_b16 v[96:97], v7 offset:40960
    v_mfma_f32_16x16x32_bf16 v[136:139], v[48:51], v[40:43], v[136:139]
    ds_read_b64_tr_b16 v[98:99], v7 offset:41984
    v_mfma_f32_16x16x32_bf16 v[140:143], v[48:51], v[44:47], v[140:143]
    ds_read_b128 v[84:87], v6 offset:34816
    v_mfma_f32_16x16x32_bf16 v[144:147], v[52:55], v[32:35], v[144:147]
    ds_read_b128 v[88:91], v6 offset:36864
    v_mfma_f32_16x16x32_bf16 v[148:151], v[52:55], v[36:39], v[148:151]
    ds_read_b128 v[92:95], v6 offset:38912
    v_mfma_f32_16x16x32_bf16 v[152:155], v[52:55], v[40:43], v[152:155]
    ds_read_b64_tr_b16 v[100:101], v7 offset:57344
    v_mfma_f32_16x16x32_bf16 v[156:159], v[52:55], v[44:47], v[156:159]
    ds_read_b64_tr_b16 v[102:103], v7 offset:58368
    s_waitcnt lgkmcnt(15)
    v_mfma_f32_16x16x32_bf16 v[160:163], v[56:59], v[32:35], v[160:163]
    ds_read_b64_tr_b16 v[104:105], v8 offset:40960
    v_mfma_f32_16x16x32_bf16 v[164:167], v[56:59], v[36:39], v[164:167]
    ds_read_b64_tr_b16 v[106:107], v8 offset:41984
    v_mfma_f32_16x16x32_bf16 v[168:171], v[56:59], v[40:43], v[168:171]
    ds_read_b64_tr_b16 v[108:109], v8 offset:57344
    v_mfma_f32_16x16x32_bf16 v[172:175], v[56:59], v[44:47], v[172:175]
    ds_read_b64_tr_b16 v[110:111], v8 offset:58368
    v_mfma_f32_16x16x32_bf16 v[176:179], v[60:63], v[32:35], v[176:179]
    ds_read_b64_tr_b16 v[112:113], v9 offset:40960
    v_mfma_f32_16x16x32_bf16 v[180:183], v[60:63], v[36:39], v[180:183]
    ds_read_b64_tr_b16 v[114:115], v9 offset:41984
    v_mfma_f32_16x16x32_bf16 v[184:187], v[60:63], v[40:43], v[184:187]
    ds_read_b64_tr_b16 v[116:117], v9 offset:57344
    v_mfma_f32_16x16x32_bf16 v[188:191], v[60:63], v[44:47], v[188:191]
    ds_read_b64_tr_b16 v[118:119], v9 offset:58368
    s_waitcnt lgkmcnt(15)
    v_mfma_f32_16x16x32_bf16 v[192:195], v[64:67], v[32:35], v[192:195]
    ds_read_b64_tr_b16 v[120:121], v10 offset:40960
    v_mfma_f32_16x16x32_bf16 v[196:199], v[64:67], v[36:39], v[196:199]
    ds_read_b64_tr_b16 v[122:123], v10 offset:41984
    v_mfma_f32_16x16x32_bf16 v[200:203], v[64:67], v[40:43], v[200:203]
    ds_read_b64_tr_b16 v[124:125], v10 offset:57344
    v_mfma_f32_16x16x32_bf16 v[204:207], v[64:67], v[44:47], v[204:207]
    ds_read_b64_tr_b16 v[126:127], v10 offset:58368
    v_mfma_f32_16x16x32_bf16 v[208:211], v[68:71], v[32:35], v[208:211]
    v_mfma_f32_16x16x32_bf16 v[212:215], v[68:71], v[36:39], v[212:215]
    v_mfma_f32_16x16x32_bf16 v[216:219], v[68:71], v[40:43], v[216:219]
    v_mfma_f32_16x16x32_bf16 v[220:223], v[68:71], v[44:47], v[220:223]
    v_mfma_f32_16x16x32_bf16 v[224:227], v[72:75], v[32:35], v[224:227]
    v_mfma_f32_16x16x32_bf16 v[228:231], v[72:75], v[36:39], v[228:231]
    v_mfma_f32_16x16x32_bf16 v[232:235], v[72:75], v[40:43], v[232:235]
    v_mfma_f32_16x16x32_bf16 v[236:239], v[72:75], v[44:47], v[236:239]
    v_mfma_f32_16x16x32_bf16 v[240:243], v[76:79], v[32:35], v[240:243]
    v_mfma_f32_16x16x32_bf16 v[244:247], v[76:79], v[36:39], v[244:247]
    v_mfma_f32_16x16x32_bf16 v[248:251], v[76:79], v[40:43], v[248:251]
    v_mfma_f32_16x16x32_bf16 v[252:255], v[76:79], v[44:47], v[252:255]
    s_waitcnt lgkmcnt(0)
    v_mfma_f32_16x16x32_bf16 v[128:131], v[96:99], v[80:83], v[128:131]
    v_mfma_f32_16x16x32_bf16 v[132:135], v[96:99], v[84:87], v[132:135]
    s_barrier
    ds_read_b128 v[32:35], v5 offset:0
    v_mfma_f32_16x16x32_bf16 v[136:139], v[96:99], v[88:91], v[136:139]
    ds_read_b64_tr_b16 v[48:49], v11 offset:0
    v_mfma_f32_16x16x32_bf16 v[140:143], v[96:99], v[92:95], v[140:143]
    ds_read_b64_tr_b16 v[50:51], v11 offset:1024
    v_mfma_f32_16x16x32_bf16 v[144:147], v[100:103], v[80:83], v[144:147]
    ds_read_b128 v[36:39], v5 offset:2048
    v_mfma_f32_16x16x32_bf16 v[148:151], v[100:103], v[84:87], v[148:151]
    ds_read_b128 v[40:43], v5 offset:4096
    v_mfma_f32_16x16x32_bf16 v[152:155], v[100:103], v[88:91], v[152:155]
    ds_read_b128 v[44:47], v5 offset:6144
    v_mfma_f32_16x16x32_bf16 v[156:159], v[100:103], v[92:95], v[156:159]
    ds_read_b64_tr_b16 v[52:53], v11 offset:16384
    v_mfma_f32_16x16x32_bf16 v[160:163], v[104:107], v[80:83], v[160:163]
    ds_read_b64_tr_b16 v[54:55], v11 offset:17408
    v_mfma_f32_16x16x32_bf16 v[164:167], v[104:107], v[84:87], v[164:167]
    ds_read_b64_tr_b16 v[56:57], v12 offset:0
    v_mfma_f32_16x16x32_bf16 v[168:171], v[104:107], v[88:91], v[168:171]
    ds_read_b64_tr_b16 v[58:59], v12 offset:1024
    v_mfma_f32_16x16x32_bf16 v[172:175], v[104:107], v[92:95], v[172:175]
    ds_read_b64_tr_b16 v[60:61], v12 offset:16384
    v_mfma_f32_16x16x32_bf16 v[176:179], v[108:111], v[80:83], v[176:179]
    ds_read_b64_tr_b16 v[62:63], v12 offset:17408
    v_mfma_f32_16x16x32_bf16 v[180:183], v[108:111], v[84:87], v[180:183]
    ds_read_b64_tr_b16 v[64:65], v13 offset:0
    v_mfma_f32_16x16x32_bf16 v[184:187], v[108:111], v[88:91], v[184:187]
    ds_read_b64_tr_b16 v[66:67], v13 offset:1024
    v_mfma_f32_16x16x32_bf16 v[188:191], v[108:111], v[92:95], v[188:191]
    ds_read_b64_tr_b16 v[68:69], v13 offset:16384
    v_mfma_f32_16x16x32_bf16 v[192:195], v[112:115], v[80:83], v[192:195]
    ds_read_b64_tr_b16 v[70:71], v13 offset:17408
    v_mfma_f32_16x16x32_bf16 v[196:199], v[112:115], v[84:87], v[196:199]
    ds_read_b64_tr_b16 v[72:73], v14 offset:0
    v_mfma_f32_16x16x32_bf16 v[200:203], v[112:115], v[88:91], v[200:203]
    ds_read_b64_tr_b16 v[74:75], v14 offset:1024
    v_mfma_f32_16x16x32_bf16 v[204:207], v[112:115], v[92:95], v[204:207]
    ds_read_b64_tr_b16 v[76:77], v14 offset:16384
    v_mfma_f32_16x16x32_bf16 v[208:211], v[116:119], v[80:83], v[208:211]
    ds_read_b64_tr_b16 v[78:79], v14 offset:17408
    v_mfma_f32_16x16x32_bf16 v[212:215], v[116:119], v[84:87], v[212:215]
    v_mfma_f32_16x16x32_bf16 v[216:219], v[116:119], v[88:91], v[216:219]
    v_mfma_f32_16x16x32_bf16 v[220:223], v[116:119], v[92:95], v[220:223]
    v_mfma_f32_16x16x32_bf16 v[224:227], v[120:123], v[80:83], v[224:227]
    v_mfma_f32_16x16x32_bf16 v[228:231], v[120:123], v[84:87], v[228:231]
    v_mfma_f32_16x16x32_bf16 v[232:235], v[120:123], v[88:91], v[232:235]
    v_mfma_f32_16x16x32_bf16 v[236:239], v[120:123], v[92:95], v[236:239]
    v_mfma_f32_16x16x32_bf16 v[240:243], v[124:127], v[80:83], v[240:243]
    v_mfma_f32_16x16x32_bf16 v[244:247], v[124:127], v[84:87], v[244:247]
    v_mfma_f32_16x16x32_bf16 v[248:251], v[124:127], v[88:91], v[248:251]
    v_mfma_f32_16x16x32_bf16 v[252:255], v[124:127], v[92:95], v[252:255]
    s_waitcnt lgkmcnt(12)
    v_mfma_f32_16x16x32_bf16 v[128:131], v[48:51], v[32:35], v[128:131]
    ds_read_b128 v[80:83], v6 offset:0
    v_mfma_f32_16x16x32_bf16 v[132:135], v[48:51], v[36:39], v[132:135]
    ds_read_b64_tr_b16 v[96:97], v11 offset:8192
    v_mfma_f32_16x16x32_bf16 v[136:139], v[48:51], v[40:43], v[136:139]
    ds_read_b64_tr_b16 v[98:99], v11 offset:9216
    v_mfma_f32_16x16x32_bf16 v[140:143], v[48:51], v[44:47], v[140:143]
    ds_read_b128 v[84:87], v6 offset:2048
    v_mfma_f32_16x16x32_bf16 v[144:147], v[52:55], v[32:35], v[144:147]
    ds_read_b128 v[88:91], v6 offset:4096
    v_mfma_f32_16x16x32_bf16 v[148:151], v[52:55], v[36:39], v[148:151]
    ds_read_b128 v[92:95], v6 offset:6144
    v_mfma_f32_16x16x32_bf16 v[152:155], v[52:55], v[40:43], v[152:155]
    ds_read_b64_tr_b16 v[100:101], v11 offset:24576
    v_mfma_f32_16x16x32_bf16 v[156:159], v[52:55], v[44:47], v[156:159]
    ds_read_b64_tr_b16 v[102:103], v11 offset:25600
    s_waitcnt lgkmcnt(15)
    v_mfma_f32_16x16x32_bf16 v[160:163], v[56:59], v[32:35], v[160:163]
    ds_read_b64_tr_b16 v[104:105], v12 offset:8192
    v_mfma_f32_16x16x32_bf16 v[164:167], v[56:59], v[36:39], v[164:167]
    ds_read_b64_tr_b16 v[106:107], v12 offset:9216
    v_mfma_f32_16x16x32_bf16 v[168:171], v[56:59], v[40:43], v[168:171]
    ds_read_b64_tr_b16 v[108:109], v12 offset:24576
    v_mfma_f32_16x16x32_bf16 v[172:175], v[56:59], v[44:47], v[172:175]
    ds_read_b64_tr_b16 v[110:111], v12 offset:25600
    v_mfma_f32_16x16x32_bf16 v[176:179], v[60:63], v[32:35], v[176:179]
    ds_read_b64_tr_b16 v[112:113], v13 offset:8192
    v_mfma_f32_16x16x32_bf16 v[180:183], v[60:63], v[36:39], v[180:183]
    ds_read_b64_tr_b16 v[114:115], v13 offset:9216
    v_mfma_f32_16x16x32_bf16 v[184:187], v[60:63], v[40:43], v[184:187]
    ds_read_b64_tr_b16 v[116:117], v13 offset:24576
    v_mfma_f32_16x16x32_bf16 v[188:191], v[60:63], v[44:47], v[188:191]
    ds_read_b64_tr_b16 v[118:119], v13 offset:25600
    s_waitcnt lgkmcnt(15)
    v_mfma_f32_16x16x32_bf16 v[192:195], v[64:67], v[32:35], v[192:195]
    ds_read_b64_tr_b16 v[120:121], v14 offset:8192
    v_mfma_f32_16x16x32_bf16 v[196:199], v[64:67], v[36:39], v[196:199]
    ds_read_b64_tr_b16 v[122:123], v14 offset:9216
    v_mfma_f32_16x16x32_bf16 v[200:203], v[64:67], v[40:43], v[200:203]
    ds_read_b64_tr_b16 v[124:125], v14 offset:24576
    v_mfma_f32_16x16x32_bf16 v[204:207], v[64:67], v[44:47], v[204:207]
    ds_read_b64_tr_b16 v[126:127], v14 offset:25600
    v_mfma_f32_16x16x32_bf16 v[208:211], v[68:71], v[32:35], v[208:211]
    v_mfma_f32_16x16x32_bf16 v[212:215], v[68:71], v[36:39], v[212:215]
    v_mfma_f32_16x16x32_bf16 v[216:219], v[68:71], v[40:43], v[216:219]
    v_mfma_f32_16x16x32_bf16 v[220:223], v[68:71], v[44:47], v[220:223]
    v_mfma_f32_16x16x32_bf16 v[224:227], v[72:75], v[32:35], v[224:227]
    v_mfma_f32_16x16x32_bf16 v[228:231], v[72:75], v[36:39], v[228:231]
    v_mfma_f32_16x16x32_bf16 v[232:235], v[72:75], v[40:43], v[232:235]
    v_mfma_f32_16x16x32_bf16 v[236:239], v[72:75], v[44:47], v[236:239]
    v_mfma_f32_16x16x32_bf16 v[240:243], v[76:79], v[32:35], v[240:243]
    v_mfma_f32_16x16x32_bf16 v[244:247], v[76:79], v[36:39], v[244:247]
    v_mfma_f32_16x16x32_bf16 v[248:251], v[76:79], v[40:43], v[248:251]
    v_mfma_f32_16x16x32_bf16 v[252:255], v[76:79], v[44:47], v[252:255]
    s_waitcnt lgkmcnt(0)
    v_mfma_f32_16x16x32_bf16 v[128:131], v[96:99], v[80:83], v[128:131]
    v_mfma_f32_16x16x32_bf16 v[132:135], v[96:99], v[84:87], v[132:135]
    s_barrier
    ds_read_b128 v[32:35], v5 offset:16384
    v_mfma_f32_16x16x32_bf16 v[136:139], v[96:99], v[88:91], v[136:139]
    ds_read_b64_tr_b16 v[48:49], v7 offset:0
    v_mfma_f32_16x16x32_bf16 v[140:143], v[96:99], v[92:95], v[140:143]
    ds_read_b64_tr_b16 v[50:51], v7 offset:1024
    v_mfma_f32_16x16x32_bf16 v[144:147], v[100:103], v[80:83], v[144:147]
    ds_read_b128 v[36:39], v5 offset:18432
    v_mfma_f32_16x16x32_bf16 v[148:151], v[100:103], v[84:87], v[148:151]
    ds_read_b128 v[40:43], v5 offset:20480
    v_mfma_f32_16x16x32_bf16 v[152:155], v[100:103], v[88:91], v[152:155]
    ds_read_b128 v[44:47], v5 offset:22528
    v_mfma_f32_16x16x32_bf16 v[156:159], v[100:103], v[92:95], v[156:159]
    ds_read_b64_tr_b16 v[52:53], v7 offset:16384
    v_mfma_f32_16x16x32_bf16 v[160:163], v[104:107], v[80:83], v[160:163]
    ds_read_b64_tr_b16 v[54:55], v7 offset:17408
    v_mfma_f32_16x16x32_bf16 v[164:167], v[104:107], v[84:87], v[164:167]
    ds_read_b64_tr_b16 v[56:57], v8 offset:0
    v_mfma_f32_16x16x32_bf16 v[168:171], v[104:107], v[88:91], v[168:171]
    ds_read_b64_tr_b16 v[58:59], v8 offset:1024
    v_mfma_f32_16x16x32_bf16 v[172:175], v[104:107], v[92:95], v[172:175]
    ds_read_b64_tr_b16 v[60:61], v8 offset:16384
    v_mfma_f32_16x16x32_bf16 v[176:179], v[108:111], v[80:83], v[176:179]
    ds_read_b64_tr_b16 v[62:63], v8 offset:17408
    v_mfma_f32_16x16x32_bf16 v[180:183], v[108:111], v[84:87], v[180:183]
    ds_read_b64_tr_b16 v[64:65], v9 offset:0
    v_mfma_f32_16x16x32_bf16 v[184:187], v[108:111], v[88:91], v[184:187]
    ds_read_b64_tr_b16 v[66:67], v9 offset:1024
    v_mfma_f32_16x16x32_bf16 v[188:191], v[108:111], v[92:95], v[188:191]
    ds_read_b64_tr_b16 v[68:69], v9 offset:16384
    v_mfma_f32_16x16x32_bf16 v[192:195], v[112:115], v[80:83], v[192:195]
    ds_read_b64_tr_b16 v[70:71], v9 offset:17408
    v_mfma_f32_16x16x32_bf16 v[196:199], v[112:115], v[84:87], v[196:199]
    ds_read_b64_tr_b16 v[72:73], v10 offset:0
    v_mfma_f32_16x16x32_bf16 v[200:203], v[112:115], v[88:91], v[200:203]
    ds_read_b64_tr_b16 v[74:75], v10 offset:1024
    v_mfma_f32_16x16x32_bf16 v[204:207], v[112:115], v[92:95], v[204:207]
    ds_read_b64_tr_b16 v[76:77], v10 offset:16384
    v_mfma_f32_16x16x32_bf16 v[208:211], v[116:119], v[80:83], v[208:211]
    ds_read_b64_tr_b16 v[78:79], v10 offset:17408
    v_mfma_f32_16x16x32_bf16 v[212:215], v[116:119], v[84:87], v[212:215]
    v_mfma_f32_16x16x32_bf16 v[216:219], v[116:119], v[88:91], v[216:219]
    v_mfma_f32_16x16x32_bf16 v[220:223], v[116:119], v[92:95], v[220:223]
    v_mfma_f32_16x16x32_bf16 v[224:227], v[120:123], v[80:83], v[224:227]
    v_mfma_f32_16x16x32_bf16 v[228:231], v[120:123], v[84:87], v[228:231]
    v_mfma_f32_16x16x32_bf16 v[232:235], v[120:123], v[88:91], v[232:235]
    v_mfma_f32_16x16x32_bf16 v[236:239], v[120:123], v[92:95], v[236:239]
    v_mfma_f32_16x16x32_bf16 v[240:243], v[124:127], v[80:83], v[240:243]
    v_mfma_f32_16x16x32_bf16 v[244:247], v[124:127], v[84:87], v[244:247]
    v_mfma_f32_16x16x32_bf16 v[248:251], v[124:127], v[88:91], v[248:251]
    v_mfma_f32_16x16x32_bf16 v[252:255], v[124:127], v[92:95], v[252:255]
    s_waitcnt lgkmcnt(12)
    v_mfma_f32_16x16x32_bf16 v[128:131], v[48:51], v[32:35], v[128:131]
    ds_read_b128 v[80:83], v6 offset:16384
    v_mfma_f32_16x16x32_bf16 v[132:135], v[48:51], v[36:39], v[132:135]
    ds_read_b64_tr_b16 v[96:97], v7 offset:8192
    v_mfma_f32_16x16x32_bf16 v[136:139], v[48:51], v[40:43], v[136:139]
    ds_read_b64_tr_b16 v[98:99], v7 offset:9216
    v_mfma_f32_16x16x32_bf16 v[140:143], v[48:51], v[44:47], v[140:143]
    ds_read_b128 v[84:87], v6 offset:18432
    v_mfma_f32_16x16x32_bf16 v[144:147], v[52:55], v[32:35], v[144:147]
    ds_read_b128 v[88:91], v6 offset:20480
    v_mfma_f32_16x16x32_bf16 v[148:151], v[52:55], v[36:39], v[148:151]
    ds_read_b128 v[92:95], v6 offset:22528
    v_mfma_f32_16x16x32_bf16 v[152:155], v[52:55], v[40:43], v[152:155]
    ds_read_b64_tr_b16 v[100:101], v7 offset:24576
    v_mfma_f32_16x16x32_bf16 v[156:159], v[52:55], v[44:47], v[156:159]
    ds_read_b64_tr_b16 v[102:103], v7 offset:25600
    s_waitcnt lgkmcnt(15)
    v_mfma_f32_16x16x32_bf16 v[160:163], v[56:59], v[32:35], v[160:163]
    ds_read_b64_tr_b16 v[104:105], v8 offset:8192
    v_mfma_f32_16x16x32_bf16 v[164:167], v[56:59], v[36:39], v[164:167]
    ds_read_b64_tr_b16 v[106:107], v8 offset:9216
    v_mfma_f32_16x16x32_bf16 v[168:171], v[56:59], v[40:43], v[168:171]
    ds_read_b64_tr_b16 v[108:109], v8 offset:24576
    v_mfma_f32_16x16x32_bf16 v[172:175], v[56:59], v[44:47], v[172:175]
    ds_read_b64_tr_b16 v[110:111], v8 offset:25600
    v_mfma_f32_16x16x32_bf16 v[176:179], v[60:63], v[32:35], v[176:179]
    ds_read_b64_tr_b16 v[112:113], v9 offset:8192
    v_mfma_f32_16x16x32_bf16 v[180:183], v[60:63], v[36:39], v[180:183]
    ds_read_b64_tr_b16 v[114:115], v9 offset:9216
    v_mfma_f32_16x16x32_bf16 v[184:187], v[60:63], v[40:43], v[184:187]
    ds_read_b64_tr_b16 v[116:117], v9 offset:24576
    v_mfma_f32_16x16x32_bf16 v[188:191], v[60:63], v[44:47], v[188:191]
    ds_read_b64_tr_b16 v[118:119], v9 offset:25600
    s_waitcnt lgkmcnt(15)
    v_mfma_f32_16x16x32_bf16 v[192:195], v[64:67], v[32:35], v[192:195]
    ds_read_b64_tr_b16 v[120:121], v10 offset:8192
    v_mfma_f32_16x16x32_bf16 v[196:199], v[64:67], v[36:39], v[196:199]
    ds_read_b64_tr_b16 v[122:123], v10 offset:9216
    v_mfma_f32_16x16x32_bf16 v[200:203], v[64:67], v[40:43], v[200:203]
    ds_read_b64_tr_b16 v[124:125], v10 offset:24576
    v_mfma_f32_16x16x32_bf16 v[204:207], v[64:67], v[44:47], v[204:207]
    ds_read_b64_tr_b16 v[126:127], v10 offset:25600
    v_mfma_f32_16x16x32_bf16 v[208:211], v[68:71], v[32:35], v[208:211]
    v_mfma_f32_16x16x32_bf16 v[212:215], v[68:71], v[36:39], v[212:215]
    v_mfma_f32_16x16x32_bf16 v[216:219], v[68:71], v[40:43], v[216:219]
    v_mfma_f32_16x16x32_bf16 v[220:223], v[68:71], v[44:47], v[220:223]
    v_mfma_f32_16x16x32_bf16 v[224:227], v[72:75], v[32:35], v[224:227]
    v_mfma_f32_16x16x32_bf16 v[228:231], v[72:75], v[36:39], v[228:231]
    ds_read_b32 v2, v1 offset:6512
    ds_read_b64 v[16:17], v26 offset:6480
    v_mfma_f32_16x16x32_bf16 v[232:235], v[72:75], v[40:43], v[232:235]
    v_mfma_f32_16x16x32_bf16 v[236:239], v[72:75], v[44:47], v[236:239]
    v_mfma_f32_16x16x32_bf16 v[240:243], v[76:79], v[32:35], v[240:243]
    v_mfma_f32_16x16x32_bf16 v[244:247], v[76:79], v[36:39], v[244:247]
    v_mfma_f32_16x16x32_bf16 v[248:251], v[76:79], v[40:43], v[248:251]
    v_mfma_f32_16x16x32_bf16 v[252:255], v[76:79], v[44:47], v[252:255]
    s_waitcnt lgkmcnt(0)
    v_mfma_f32_16x16x32_bf16 v[128:131], v[96:99], v[80:83], v[128:131]
    v_mfma_f32_16x16x32_bf16 v[132:135], v[96:99], v[84:87], v[132:135]
    v_cmp_gt_u32 vcc, 8, v2
    s_cbranch_vccz Lm_f7_ok
    s_mov_b32 s10, 0
Lm_f7:
    ds_read_b32 v2, v1 offset:6512
    s_waitcnt lgkmcnt(0)
    v_cmp_gt_u32 vcc, 8, v2
    s_cbranch_vccz Lm_f7_ok
    s_add_u32 s10, s10, 1
    s_cmp_lt_u32 s10, 300000
    s_cbranch_scc1 Lm_f7
Lm_f7_ok:
    ds_read_b128 v[32:35], v5 offset:32768
    v_mfma_f32_16x16x32_bf16 v[136:139], v[96:99], v[88:91], v[136:139]
    ds_read_b64_tr_b16 v[48:49], v7 offset:32768
    v_mfma_f32_16x16x32_bf16 v[140:143], v[96:99], v[92:95], v[140:143]
    ds_read_b64_tr_b16 v[50:51], v7 offset:33792
    v_mfma_f32_16x16x32_bf16 v[144:147], v[100:103], v[80:83], v[144:147]
    ds_read_b128 v[36:39], v5 offset:34816
    v_mfma_f32_16x16x32_bf16 v[148:151], v[100:103], v[84:87], v[148:151]
    ds_read_b128 v[40:43], v5 offset:36864
    v_mfma_f32_16x16x32_bf16 v[152:155], v[100:103], v[88:91], v[152:155]
    ds_read_b128 v[44:47], v5 offset:38912
    v_mfma_f32_16x16x32_bf16 v[156:159], v[100:103], v[92:95], v[156:159]
    ds_read_b64_tr_b16 v[52:53], v7 offset:49152
    v_mfma_f32_16x16x32_bf16 v[160:163], v[104:107], v[80:83], v[160:163]
    ds_read_b64_tr_b16 v[54:55], v7 offset:50176
    v_mfma_f32_16x16x32_bf16 v[164:167], v[104:107], v[84:87], v[164:167]
    ds_read_b64_tr_b16 v[56:57], v8 offset:32768
    v_mfma_f32_16x16x32_bf16 v[168:171], v[104:107], v[88:91], v[168:171]
    ds_read_b64_tr_b16 v[58:59], v8 offset:33792
    v_mfma_f32_16x16x32_bf16 v[172:175], v[104:107], v[92:95], v[172:175]
    ds_read_b64_tr_b16 v[60:61], v8 offset:49152
    v_mfma_f32_16x16x32_bf16 v[176:179], v[108:111], v[80:83], v[176:179]
    ds_read_b64_tr_b16 v[62:63], v8 offset:50176
    v_mfma_f32_16x16x32_bf16 v[180:183], v[108:111], v[84:87], v[180:183]
    ds_read_b64_tr_b16 v[64:65], v9 offset:32768
    v_mfma_f32_16x16x32_bf16 v[184:187], v[108:111], v[88:91], v[184:187]
    ds_read_b64_tr_b16 v[66:67], v9 offset:33792
    v_mfma_f32_16x16x32_bf16 v[188:191], v[108:111], v[92:95], v[188:191]
    ds_read_b64_tr_b16 v[68:69], v9 offset:49152
    v_mfma_f32_16x16x32_bf16 v[192:195], v[112:115], v[80:83], v[192:195]
    ds_read_b64_tr_b16 v[70:71], v9 offset:50176
    v_mfma_f32_16x16x32_bf16 v[196:199], v[112:115], v[84:87], v[196:199]
    ds_read_b64_tr_b16 v[72:73], v10 offset:32768
    v_mfma_f32_16x16x32_bf16 v[200:203], v[112:115], v[88:91], v[200:203]
    ds_read_b64_tr_b16 v[74:75], v10 offset:33792
    v_mfma_f32_16x16x32_bf16 v[204:207], v[112:115], v[92:95], v[204:207]
    ds_read_b64_tr_b16 v[76:77], v10 offset:49152
    v_mfma_f32_16x16x32_bf16 v[208:211], v[116:119], v[80:83], v[208:211]
    ds_read_b64_tr_b16 v[78:79], v10 offset:50176
    v_mfma_f32_16x16x32_bf16 v[212:215], v[116:119], v[84:87], v[212:215]
    v_mfma_f32_16x16x32_bf16 v[216:219], v[116:119], v[88:91], v[216:219]
    v_mfma_f32_16x16x32_bf16 v[220:223], v[116:119], v[92:95], v[220:223]
    v_mfma_f32_16x16x32_bf16 v[224:227], v[120:123], v[80:83], v[224:227]
    v_mfma_f32_16x16x32_bf16 v[228:231], v[120:123], v[84:87], v[228:231]
    v_mfma_f32_16x16x32_bf16 v[232:235], v[120:123], v[88:91], v[232:235]
    v_mfma_f32_16x16x32_bf16 v[236:239], v[120:123], v[92:95], v[236:239]
    v_mfma_f32_16x16x32_bf16 v[240:243], v[124:127], v[80:83], v[240:243]
    v_mfma_f32_16x16x32_bf16 v[244:247], v[124:127], v[84:87], v[244:247]
    v_mfma_f32_16x16x32_bf16 v[248:251], v[124:127], v[88:91], v[248:251]
    v_mfma_f32_16x16x32_bf16 v[252:255], v[124:127], v[92:95], v[252:255]
    s_setprio 3
    s_waitcnt lgkmcnt(12)
    v_mfma_f32_16x16x32_bf16 v[128:131], v[48:51], v[32:35], v[128:131]
    ds_read_b128 v[80:83], v6 offset:32768
    ds_read_b64_tr_b16 v[96:97], v7 offset:40960
    v_mfma_f32_16x16x32_bf16 v[132:135], v[48:51], v[36:39], v[132:135]
    ds_read_b64_tr_b16 v[98:99], v7 offset:41984
    ds_read_b128 v[84:87], v6 offset:34816
    v_mfma_f32_16x16x32_bf16 v[136:139], v[48:51], v[40:43], v[136:139]
    ds_read_b128 v[88:91], v6 offset:36864
    ds_read_b128 v[92:95], v6 offset:38912
    v_mfma_f32_16x16x32_bf16 v[140:143], v[48:51], v[44:47], v[140:143]
    ds_read_b64_tr_b16 v[100:101], v7 offset:57344
    ds_read_b64_tr_b16 v[102:103], v7 offset:58368
    v_mfma_f32_16x16x32_bf16 v[144:147], v[52:55], v[32:35], v[144:147]
    ds_read_b64_tr_b16 v[104:105], v8 offset:40960
    ds_read_b64_tr_b16 v[106:107], v8 offset:41984
    v_mfma_f32_16x16x32_bf16 v[148:151], v[52:55], v[36:39], v[148:151]
    ds_read_b64_tr_b16 v[108:109], v8 offset:57344
    ds_read_b64_tr_b16 v[110:111], v8 offset:58368
    v_mfma_f32_16x16x32_bf16 v[152:155], v[52:55], v[40:43], v[152:155]
    ds_read_b64_tr_b16 v[112:113], v9 offset:40960
    ds_read_b64_tr_b16 v[114:115], v9 offset:41984
    v_mfma_f32_16x16x32_bf16 v[156:159], v[52:55], v[44:47], v[156:159]
    ds_read_b64_tr_b16 v[116:117], v9 offset:57344
    ds_read_b64_tr_b16 v[118:119], v9 offset:58368
    s_waitcnt lgkmcnt(15)
    v_mfma_f32_16x16x32_bf16 v[160:163], v[56:59], v[32:35], v[160:163]
    ds_read_b64_tr_b16 v[120:121], v10 offset:40960
    v_mfma_f32_16x16x32_bf16 v[164:167], v[56:59], v[36:39], v[164:167]
    ds_read_b64_tr_b16 v[122:123], v10 offset:41984
    v_mfma_f32_16x16x32_bf16 v[168:171], v[56:59], v[40:43], v[168:171]
    ds_read_b64_tr_b16 v[124:125], v10 offset:57344
    v_mfma_f32_16x16x32_bf16 v[172:175], v[56:59], v[44:47], v[172:175]
    ds_read_b64_tr_b16 v[126:127], v10 offset:58368
    v_mov_b32 v3, 8
    s_mov_b64 exec, 1
    ds_write_b32 v25, v3 offset:6400
    s_mov_b64 exec, -1
    v_mfma_f32_16x16x32_bf16 v[176:179], v[60:63], v[32:35], v[176:179]
    v_mfma_f32_16x16x32_bf16 v[180:183], v[60:63], v[36:39], v[180:183]
    v_mfma_f32_16x16x32_bf16 v[184:187], v[60:63], v[40:43], v[184:187]
    v_mfma_f32_16x16x32_bf16 v[188:191], v[60:63], v[44:47], v[188:191]
    s_waitcnt lgkmcnt(13)
    v_mfma_f32_16x16x32_bf16 v[128:131], v[96:99], v[80:83], v[128:131]
    v_mfma_f32_16x16x32_bf16 v[132:135], v[96:99], v[84:87], v[132:135]
    v_mfma_f32_16x16x32_bf16 v[136:139], v[96:99], v[88:91], v[136:139]
    v_mfma_f32_16x16x32_bf16 v[140:143], v[96:99], v[92:95], v[140:143]
    v_mfma_f32_16x16x32_bf16 v[144:147], v[100:103], v[80:83], v[144:147]
    v_mfma_f32_16x16x32_bf16 v[148:151], v[100:103], v[84:87], v[148:151]
    v_mfma_f32_16x16x32_bf16 v[152:155], v[100:103], v[88:91], v[152:155]
    v_mfma_f32_16x16x32_bf16 v[156:159], v[100:103], v[92:95], v[156:159]
    v_mfma_f32_16x16x32_bf16 v[192:195], v[64:67], v[32:35], v[192:195]
    v_mfma_f32_16x16x32_bf16 v[196:199], v[64:67], v[36:39], v[196:199]
    v_mfma_f32_16x16x32_bf16 v[200:203], v[64:67], v[40:43], v[200:203]
    v_mfma_f32_16x16x32_bf16 v[204:207], v[64:67], v[44:47], v[204:207]
    v_cvt_pk_bf16_f32 v128, 0, v128
    v_cvt_pk_bf16_f32 v144, 0, v144
    v_mfma_f32_16x16x32_bf16 v[208:211], v[68:71], v[32:35], v[208:211]
    v_cvt_pk_bf16_f32 v129, 0, v129
    v_cvt_pk_bf16_f32 v145, 0, v145
    v_mfma_f32_16x16x32_bf16 v[212:215], v[68:71], v[36:39], v[212:215]
    v_cvt_pk_bf16_f32 v130, 0, v130
    v_cvt_pk_bf16_f32 v146, 0, v146
    v_mfma_f32_16x16x32_bf16 v[216:219], v[68:71], v[40:43], v[216:219]
    v_cvt_pk_bf16_f32 v131, 0, v131
    v_cvt_pk_bf16_f32 v147, 0, v147
    v_mfma_f32_16x16x32_bf16 v[220:223], v[68:71], v[44:47], v[220:223]
    v_cvt_pk_bf16_f32 v132, 0, v132
    v_cvt_pk_bf16_f32 v148, 0, v148
    s_waitcnt lgkmcnt(9)
    s_mov_b64 exec, 1
    ds_write_b32 v25, v18 offset:6464
    s_mov_b64 exec, -1
    v_mfma_f32_16x16x32_bf16 v[160:163], v[104:107], v[80:83], v[160:163]
    v_cvt_pk_bf16_f32 v133, 0, v133
    v_cvt_pk_bf16_f32 v149, 0, v149
    v_mfma_f32_16x16x32_bf16 v[164:167], v[104:107], v[84:87], v[164:167]
    v_cvt_pk_bf16_f32 v134, 0, v134
    v_cvt_pk_bf16_f32 v150, 0, v150
    v_mfma_f32_16x16x32_bf16 v[168:171], v[104:107], v[88:91], v[168:171]
    v_cvt_pk_bf16_f32 v135, 0, v135
    v_cvt_pk_bf16_f32 v151, 0, v151
    v_mfma_f32_16x16x32_bf16 v[172:175], v[104:107], v[92:95], v[172:175]
    v_mul_f32 v128, v128, v144
    v_mul_f32 v129, v129, v145
    v_mfma_f32_16x16x32_bf16 v[176:179], v[108:111], v[80:83], v[176:179]
    v_mul_f32 v130, v130, v146
    v_mul_f32 v131, v131, v147
    v_mfma_f32_16x16x32_bf16 v[180:183], v[108:111], v[84:87], v[180:183]
    v_mul_f32 v132, v132, v148
    v_mul_f32 v133, v133, v149
    v_mfma_f32_16x16x32_bf16 v[184:187], v[108:111], v[88:91], v[184:187]
    v_mul_f32 v134, v134, v150
    v_mul_f32 v135, v135, v151
    v_mfma_f32_16x16x32_bf16 v[188:191], v[108:111], v[92:95], v[188:191]
    v_cvt_pk_bf16_f32 v144, v128, v129
    v_cvt_pk_bf16_f32 v146, v132, v133
    v_mfma_f32_16x16x32_bf16 v[224:227], v[72:75], v[32:35], v[224:227]
    v_cvt_pk_bf16_f32 v145, v130, v131
    v_cvt_pk_bf16_f32 v147, v134, v135
    v_mfma_f32_16x16x32_bf16 v[228:231], v[72:75], v[36:39], v[228:231]
    v_permlane16_swap_b32 v144, v146
    v_permlane16_swap_b32 v145, v147
    v_mfma_f32_16x16x32_bf16 v[232:235], v[72:75], v[40:43], v[232:235]
    buffer_store_dwordx4 v[144:147], v15, s[12:15], s60 offen offset:0 sc1
    v_cvt_pk_bf16_f32 v136, 0, v136
    v_mfma_f32_16x16x32_bf16 v[236:239], v[72:75], v[44:47], v[236:239]
    v_cvt_pk_bf16_f32 v152, 0, v152
    v_cvt_pk_bf16_f32 v137, 0, v137
    v_mfma_f32_16x16x32_bf16 v[240:243], v[76:79], v[32:35], v[240:243]
    v_cvt_pk_bf16_f32 v153, 0, v153
    v_cvt_pk_bf16_f32 v138, 0, v138
    v_mfma_f32_16x16x32_bf16 v[244:247], v[76:79], v[36:39], v[244:247]
    v_cvt_pk_bf16_f32 v154, 0, v154
    v_cvt_pk_bf16_f32 v139, 0, v139
    v_mfma_f32_16x16x32_bf16 v[248:251], v[76:79], v[40:43], v[248:251]
    v_cvt_pk_bf16_f32 v155, 0, v155
    v_cvt_pk_bf16_f32 v140, 0, v140
    v_mfma_f32_16x16x32_bf16 v[252:255], v[76:79], v[44:47], v[252:255]
    v_cvt_pk_bf16_f32 v156, 0, v156
    v_cvt_pk_bf16_f32 v141, 0, v141
    s_waitcnt lgkmcnt(6)
    v_mfma_f32_16x16x32_bf16 v[192:195], v[112:115], v[80:83], v[192:195]
    v_cvt_pk_bf16_f32 v157, 0, v157
    v_cvt_pk_bf16_f32 v142, 0, v142
    v_mfma_f32_16x16x32_bf16 v[196:199], v[112:115], v[84:87], v[196:199]
    v_cvt_pk_bf16_f32 v158, 0, v158
    v_cvt_pk_bf16_f32 v143, 0, v143
    v_mfma_f32_16x16x32_bf16 v[200:203], v[112:115], v[88:91], v[200:203]
    v_cvt_pk_bf16_f32 v159, 0, v159
    v_mul_f32 v136, v136, v152
    v_mfma_f32_16x16x32_bf16 v[204:207], v[112:115], v[92:95], v[204:207]
    v_mul_f32 v137, v137, v153
    v_mul_f32 v138, v138, v154
    v_mfma_f32_16x16x32_bf16 v[208:211], v[116:119], v[80:83], v[208:211]
    v_mul_f32 v139, v139, v155
    v_mul_f32 v140, v140, v156
    v_mfma_f32_16x16x32_bf16 v[212:215], v[116:119], v[84:87], v[212:215]
    v_mul_f32 v141, v141, v157
    v_mul_f32 v142, v142, v158
    v_mfma_f32_16x16x32_bf16 v[216:219], v[116:119], v[88:91], v[216:219]
    v_mul_f32 v143, v143, v159
    v_cvt_pk_bf16_f32 v152, v136, v137
    v_mfma_f32_16x16x32_bf16 v[220:223], v[116:119], v[92:95], v[220:223]
    v_cvt_pk_bf16_f32 v154, v140, v141
    v_cvt_pk_bf16_f32 v153, v138, v139
    s_waitcnt lgkmcnt(2)
    v_mfma_f32_16x16x32_bf16 v[224:227], v[120:123], v[80:83], v[224:227]
    v_cvt_pk_bf16_f32 v155, v142, v143
    v_permlane16_swap_b32 v152, v154
    v_mfma_f32_16x16x32_bf16 v[228:231], v[120:123], v[84:87], v[228:231]
    v_permlane16_swap_b32 v153, v155
    buffer_store_dwordx4 v[152:155], v15, s[12:15], s60 offen offset:1024 sc1
    v_mfma_f32_16x16x32_bf16 v[232:235], v[120:123], v[88:91], v[232:235]
    v_cvt_pk_bf16_f32 v160, 0, v160
    v_cvt_pk_bf16_f32 v176, 0, v176
    v_mfma_f32_16x16x32_bf16 v[236:239], v[120:123], v[92:95], v[236:239]
    v_cvt_pk_bf16_f32 v161, 0, v161
    v_cvt_pk_bf16_f32 v177, 0, v177
    v_mfma_f32_16x16x32_bf16 v[240:243], v[124:127], v[80:83], v[240:243]
    v_cvt_pk_bf16_f32 v162, 0, v162
    v_cvt_pk_bf16_f32 v178, 0, v178
    v_mfma_f32_16x16x32_bf16 v[244:247], v[124:127], v[84:87], v[244:247]
    v_cvt_pk_bf16_f32 v163, 0, v163
    v_cvt_pk_bf16_f32 v179, 0, v179
    v_mfma_f32_16x16x32_bf16 v[248:251], v[124:127], v[88:91], v[248:251]
    v_cvt_pk_bf16_f32 v164, 0, v164
    v_cvt_pk_bf16_f32 v180, 0, v180
    v_mfma_f32_16x16x32_bf16 v[252:255], v[124:127], v[92:95], v[252:255]
    v_cvt_pk_bf16_f32 v165, 0, v165
    v_cvt_pk_bf16_f32 v181, 0, v181
    v_cvt_pk_bf16_f32 v166, 0, v166
    v_cvt_pk_bf16_f32 v182, 0, v182
    v_cvt_pk_bf16_f32 v167, 0, v167
    v_cvt_pk_bf16_f32 v183, 0, v183
    v_mul_f32 v160, v160, v176
    v_mul_f32 v161, v161, v177
    v_mul_f32 v162, v162, v178
    v_mul_f32 v163, v163, v179
    v_mul_f32 v164, v164, v180
    v_mul_f32 v165, v165, v181
    v_mul_f32 v166, v166, v182
    v_mul_f32 v167, v167, v183
    v_cvt_pk_bf16_f32 v176, v160, v161
    v_cvt_pk_bf16_f32 v178, v164, v165
    v_cvt_pk_bf16_f32 v177, v162, v163
    v_cvt_pk_bf16_f32 v179, v166, v167
    v_permlane16_swap_b32 v176, v178
    s_nop 0
    v_permlane16_swap_b32 v177, v179
    buffer_store_dwordx4 v[176:179], v15, s[12:15], s60 offen offset:2048 sc1
    v_cvt_pk_bf16_f32 v168, 0, v168
    v_cvt_pk_bf16_f32 v184, 0, v184
    v_cvt_pk_bf16_f32 v169, 0, v169
    v_cvt_pk_bf16_f32 v185, 0, v185
    v_cvt_pk_bf16_f32 v170, 0, v170
    v_cvt_pk_bf16_f32 v186, 0, v186
    v_cvt_pk_bf16_f32 v171, 0, v171
    v_cvt_pk_bf16_f32 v187, 0, v187
    v_cvt_pk_bf16_f32 v172, 0, v172
    v_cvt_pk_bf16_f32 v188, 0, v188
    v_cvt_pk_bf16_f32 v173, 0, v173
    v_cvt_pk_bf16_f32 v189, 0, v189
    v_cvt_pk_bf16_f32 v174, 0, v174
    v_cvt_pk_bf16_f32 v190, 0, v190
    v_cvt_pk_bf16_f32 v175, 0, v175
    v_cvt_pk_bf16_f32 v191, 0, v191
    v_mul_f32 v168, v168, v184
    v_mul_f32 v169, v169, v185
    v_mul_f32 v170, v170, v186
    v_mul_f32 v171, v171, v187
    v_mul_f32 v172, v172, v188
    v_mul_f32 v173, v173, v189
    v_mul_f32 v174, v174, v190
    v_mul_f32 v175, v175, v191
    v_cvt_pk_bf16_f32 v184, v168, v169
    v_cvt_pk_bf16_f32 v186, v172, v173
    v_cvt_pk_bf16_f32 v185, v170, v171
    v_cvt_pk_bf16_f32 v187, v174, v175
    v_permlane16_swap_b32 v184, v186
    s_nop 0
    v_permlane16_swap_b32 v185, v187
    buffer_store_dwordx4 v[184:187], v15, s[12:15], s60 offen offset:3072 sc1
    v_cvt_pk_bf16_f32 v192, 0, v192
    v_cvt_pk_bf16_f32 v208, 0, v208
    v_cvt_pk_bf16_f32 v193, 0, v193
    v_cvt_pk_bf16_f32 v209, 0, v209
    v_cvt_pk_bf16_f32 v194, 0, v194
    v_cvt_pk_bf16_f32 v210, 0, v210
    v_cvt_pk_bf16_f32 v195, 0, v195
    v_cvt_pk_bf16_f32 v211, 0, v211
    v_cvt_pk_bf16_f32 v196, 0, v196
    v_cvt_pk_bf16_f32 v212, 0, v212
    v_cvt_pk_bf16_f32 v197, 0, v197
    v_cvt_pk_bf16_f32 v213, 0, v213
    v_cvt_pk_bf16_f32 v198, 0, v198
    v_cvt_pk_bf16_f32 v214, 0, v214
    v_cvt_pk_bf16_f32 v199, 0, v199
    v_cvt_pk_bf16_f32 v215, 0, v215
    v_mul_f32 v192, v192, v208
    v_mul_f32 v193, v193, v209
    v_mul_f32 v194, v194, v210
    v_mul_f32 v195, v195, v211
    v_mul_f32 v196, v196, v212
    v_mul_f32 v197, v197, v213
    v_mul_f32 v198, v198, v214
    v_mul_f32 v199, v199, v215
    v_cvt_pk_bf16_f32 v208, v192, v193
    v_cvt_pk_bf16_f32 v210, v196, v197
    v_cvt_pk_bf16_f32 v209, v194, v195
    v_cvt_pk_bf16_f32 v211, v198, v199
    v_permlane16_swap_b32 v208, v210
    s_nop 0
    v_permlane16_swap_b32 v209, v211
    buffer_store_dwordx4 v[208:211], v15, s[12:15], s61 offen offset:0 sc1
    v_cvt_pk_bf16_f32 v200, 0, v200
    v_cvt_pk_bf16_f32 v216, 0, v216
    v_cvt_pk_bf16_f32 v201, 0, v201
    v_cvt_pk_bf16_f32 v217, 0, v217
    v_cvt_pk_bf16_f32 v202, 0, v202
    v_cvt_pk_bf16_f32 v218, 0, v218
    v_cvt_pk_bf16_f32 v203, 0, v203
    v_cvt_pk_bf16_f32 v219, 0, v219
    v_cvt_pk_bf16_f32 v204, 0, v204
    v_cvt_pk_bf16_f32 v220, 0, v220
    v_cvt_pk_bf16_f32 v205, 0, v205
    v_cvt_pk_bf16_f32 v221, 0, v221
    v_cvt_pk_bf16_f32 v206, 0, v206
    v_cvt_pk_bf16_f32 v222, 0, v222
    v_cvt_pk_bf16_f32 v207, 0, v207
    v_cvt_pk_bf16_f32 v223, 0, v223
    v_mul_f32 v200, v200, v216
    v_mul_f32 v201, v201, v217
    v_mul_f32 v202, v202, v218
    v_mul_f32 v203, v203, v219
    v_mul_f32 v204, v204, v220
    v_mul_f32 v205, v205, v221
    v_mul_f32 v206, v206, v222
    v_mul_f32 v207, v207, v223
    v_cvt_pk_bf16_f32 v216, v200, v201
    v_cvt_pk_bf16_f32 v218, v204, v205
    v_cvt_pk_bf16_f32 v217, v202, v203
    v_cvt_pk_bf16_f32 v219, v206, v207
    v_permlane16_swap_b32 v216, v218
    s_nop 0
    v_permlane16_swap_b32 v217, v219
    buffer_store_dwordx4 v[216:219], v15, s[12:15], s61 offen offset:1024 sc1
    v_cvt_pk_bf16_f32 v224, 0, v224
    v_cvt_pk_bf16_f32 v240, 0, v240
    v_cvt_pk_bf16_f32 v225, 0, v225
    v_cvt_pk_bf16_f32 v241, 0, v241
    v_cvt_pk_bf16_f32 v226, 0, v226
    v_cvt_pk_bf16_f32 v242, 0, v242
    v_cvt_pk_bf16_f32 v227, 0, v227
    v_cvt_pk_bf16_f32 v243, 0, v243
    v_cvt_pk_bf16_f32 v228, 0, v228
    v_cvt_pk_bf16_f32 v244, 0, v244
    v_cvt_pk_bf16_f32 v229, 0, v229
    v_cvt_pk_bf16_f32 v245, 0, v245
    v_cvt_pk_bf16_f32 v230, 0, v230
    v_cvt_pk_bf16_f32 v246, 0, v246
    v_cvt_pk_bf16_f32 v231, 0, v231
    v_cvt_pk_bf16_f32 v247, 0, v247
    v_mul_f32 v224, v224, v240
    v_mul_f32 v225, v225, v241
    v_mul_f32 v226, v226, v242
    v_mul_f32 v227, v227, v243
    v_mul_f32 v228, v228, v244
    v_mul_f32 v229, v229, v245
    v_mul_f32 v230, v230, v246
    v_mul_f32 v231, v231, v247
    v_cvt_pk_bf16_f32 v240, v224, v225
    v_cvt_pk_bf16_f32 v242, v228, v229
    v_cvt_pk_bf16_f32 v241, v226, v227
    v_cvt_pk_bf16_f32 v243, v230, v231
    v_permlane16_swap_b32 v240, v242
    s_nop 0
    v_permlane16_swap_b32 v241, v243
    buffer_store_dwordx4 v[240:243], v15, s[12:15], s61 offen offset:2048 sc1
    v_cvt_pk_bf16_f32 v232, 0, v232
    v_cvt_pk_bf16_f32 v248, 0, v248
    v_cvt_pk_bf16_f32 v233, 0, v233
    v_cvt_pk_bf16_f32 v249, 0, v249
    v_cvt_pk_bf16_f32 v234, 0, v234
    v_cvt_pk_bf16_f32 v250, 0, v250
    v_cvt_pk_bf16_f32 v235, 0, v235
    v_cvt_pk_bf16_f32 v251, 0, v251
    v_cvt_pk_bf16_f32 v236, 0, v236
    v_cvt_pk_bf16_f32 v252, 0, v252
    v_cvt_pk_bf16_f32 v237, 0, v237
    v_cvt_pk_bf16_f32 v253, 0, v253
    v_cvt_pk_bf16_f32 v238, 0, v238
    v_cvt_pk_bf16_f32 v254, 0, v254
    v_cvt_pk_bf16_f32 v239, 0, v239
    ds_read_b32 v2, v27 offset:6432
    v_cvt_pk_bf16_f32 v255, 0, v255
    v_mul_f32 v232, v232, v248
    v_mul_f32 v233, v233, v249
    v_mul_f32 v234, v234, v250
    v_mul_f32 v235, v235, v251
    v_mul_f32 v236, v236, v252
    v_mul_f32 v237, v237, v253
    v_mul_f32 v238, v238, v254
    v_mul_f32 v239, v239, v255
    v_cvt_pk_bf16_f32 v248, v232, v233
    v_cvt_pk_bf16_f32 v250, v236, v237
    v_cvt_pk_bf16_f32 v249, v234, v235
    v_cvt_pk_bf16_f32 v251, v238, v239
    v_permlane16_swap_b32 v248, v250
    s_nop 0
    v_permlane16_swap_b32 v249, v251
    buffer_store_dwordx4 v[248:251], v15, s[12:15], s61 offen offset:3072 sc1
    s_waitcnt lgkmcnt(0)
    v_cmp_gt_u32 vcc, 1, v2
    s_cbranch_vccz Lm_rdy_ok
    s_waitcnt vmcnt(0)
    buffer_store_dwordx2 v[16:17], v19, s[12:15], s52 offen sc1
    s_mov_b64 exec, 1
    ds_write_b32 v25, v26 offset:6464
    s_mov_b64 exec, -1
    s_branch Lm_rw
Lm_svc:
    v_mov_b32 v3, 8
    s_mov_b64 exec, 1
    ds_write_b32 v25, v3 offset:6400
    s_mov_b64 exec, -1
    ds_read_b64 v[16:17], v26 offset:6480
    s_lshl_b32 s52, s2, 2
    s_add_u32 s52, s52, s5
    s_lshl_b32 s52, s52, 7
    s_add_u32 s52, s52, 15089664
    s_mov_b32 s92, s16
    s_and_b32 s93, s17, 0xffff
    s_mov_b32 s94, 2097152
    s_mov_b32 s95, 0x20000
    global_load_dwordx4 v[96:99], v15, s[42:43]
    s_sub_u32 s64, s2, 224
    s_lshl_b32 s64, s64, 2
    s_add_u32 s64, s64, s5
    s_lshl_b32 s62, s64, 14
    s_lshl_b32 s63, s64, 6
    s_add_u32 s63, s63, 14680064
    buffer_load_dwordx4 v[32:35], v15, s[92:95], s62 offen offset:0
    buffer_load_dwordx4 v[36:39], v15, s[92:95], s62 offen offset:1024
    buffer_load_dwordx4 v[40:43], v15, s[92:95], s62 offen offset:2048
    buffer_load_dwordx4 v[44:47], v15, s[92:95], s62 offen offset:3072
    s_add_u32 s62, s62, 4096
    buffer_load_dwordx4 v[48:51], v15, s[92:95], s62 offen offset:0
    buffer_load_dwordx4 v[52:55], v15, s[92:95], s62 offen offset:1024
    buffer_load_dwordx4 v[56:59], v15, s[92:95], s62 offen offset:2048
    buffer_load_dwordx4 v[60:63], v15, s[92:95], s62 offen offset:3072
    s_add_u32 s62, s62, 4096
    buffer_load_dwordx4 v[64:67], v15, s[92:95], s62 offen offset:0
    buffer_load_dwordx4 v[68:71], v15, s[92:95], s62 offen offset:1024
    buffer_load_dwordx4 v[72:75], v15, s[92:95], s62 offen offset:2048
    buffer_load_dwordx4 v[76:79], v15, s[92:95], s62 offen offset:3072
    s_add_u32 s62, s62, 4096
    buffer_load_dwordx4 v[80:83], v15, s[92:95], s62 offen offset:0
    buffer_load_dwordx4 v[84:87], v15, s[92:95], s62 offen offset:1024
    buffer_load_dwordx4 v[88:91], v15, s[92:95], s62 offen offset:2048
    buffer_load_dwordx4 v[92:95], v15, s[92:95], s62 offen offset:3072
    s_waitcnt vmcnt(16)
    v_lshlrev_b32 v100, 16, v96
    v_and_b32 v101, 0xffff0000, v96
    v_lshlrev_b32 v102, 16, v97
    v_and_b32 v103, 0xffff0000, v97
    v_lshlrev_b32 v104, 16, v98
    v_and_b32 v105, 0xffff0000, v98
    v_lshlrev_b32 v106, 16, v99
    v_and_b32 v107, 0xffff0000, v99
    s_mov_b32 s11, 0xffff0000
    s_waitcnt vmcnt(12)
    v_lshlrev_b32 v108, 16, v32
    v_and_b32 v109, s11, v32
    v_lshlrev_b32 v110, 16, v33
    v_and_b32 v111, s11, v33
    v_lshlrev_b32 v112, 16, v34
    v_and_b32 v113, s11, v34
    v_lshlrev_b32 v114, 16, v35
    v_and_b32 v115, s11, v35
    v_mul_f32 v108, v108, v100
    v_mul_f32 v109, v109, v101
    v_mul_f32 v110, v110, v102
    v_mul_f32 v111, v111, v103
    v_mul_f32 v112, v112, v104
    v_mul_f32 v113, v113, v105
    v_mul_f32 v114, v114, v106
    v_mul_f32 v115, v115, v107
    v_cvt_pk_bf16_f32 v108, 0, v108
    v_cvt_pk_bf16_f32 v109, 0, v109
    v_cvt_pk_bf16_f32 v110, 0, v110
    v_cvt_pk_bf16_f32 v111, 0, v111
    v_cvt_pk_bf16_f32 v112, 0, v112
    v_cvt_pk_bf16_f32 v113, 0, v113
    v_cvt_pk_bf16_f32 v114, 0, v114
    v_cvt_pk_bf16_f32 v115, 0, v115
    v_add_f32 v108, v108, v109
    v_add_f32 v110, v110, v111
    v_add_f32 v112, v112, v113
    v_add_f32 v114, v114, v115
    v_add_f32 v108, v108, v110
    v_add_f32 v112, v112, v114
    v_add_f32 v116, v108, v112
    v_lshlrev_b32 v108, 16, v36
    v_and_b32 v109, s11, v36
    v_lshlrev_b32 v110, 16, v37
    v_and_b32 v111, s11, v37
    v_lshlrev_b32 v112, 16, v38
    v_and_b32 v113, s11, v38
    v_lshlrev_b32 v114, 16, v39
    v_and_b32 v115, s11, v39
    v_mul_f32 v108, v108, v100
    v_mul_f32 v109, v109, v101
    v_mul_f32 v110, v110, v102
    v_mul_f32 v111, v111, v103
    v_mul_f32 v112, v112, v104
    v_mul_f32 v113, v113, v105
    v_mul_f32 v114, v114, v106
    v_mul_f32 v115, v115, v107
    v_cvt_pk_bf16_f32 v108, 0, v108
    v_cvt_pk_bf16_f32 v109, 0, v109
    v_cvt_pk_bf16_f32 v110, 0, v110
    v_cvt_pk_bf16_f32 v111, 0, v111
    v_cvt_pk_bf16_f32 v112, 0, v112
    v_cvt_pk_bf16_f32 v113, 0, v113
    v_cvt_pk_bf16_f32 v114, 0, v114
    v_cvt_pk_bf16_f32 v115, 0, v115
    v_add_f32 v108, v108, v109
    v_add_f32 v110, v110, v111
    v_add_f32 v112, v112, v113
    v_add_f32 v114, v114, v115
    v_add_f32 v108, v108, v110
    v_add_f32 v112, v112, v114
    v_add_f32 v117, v108, v112
    v_lshlrev_b32 v108, 16, v40
    v_and_b32 v109, s11, v40
    v_lshlrev_b32 v110, 16, v41
    v_and_b32 v111, s11, v41
    v_lshlrev_b32 v112, 16, v42
    v_and_b32 v113, s11, v42
    v_lshlrev_b32 v114, 16, v43
    v_and_b32 v115, s11, v43
    v_mul_f32 v108, v108, v100
    v_mul_f32 v109, v109, v101
    v_mul_f32 v110, v110, v102
    v_mul_f32 v111, v111, v103
    v_mul_f32 v112, v112, v104
    v_mul_f32 v113, v113, v105
    v_mul_f32 v114, v114, v106
    v_mul_f32 v115, v115, v107
    v_cvt_pk_bf16_f32 v108, 0, v108
    v_cvt_pk_bf16_f32 v109, 0, v109
    v_cvt_pk_bf16_f32 v110, 0, v110
    v_cvt_pk_bf16_f32 v111, 0, v111
    v_cvt_pk_bf16_f32 v112, 0, v112
    v_cvt_pk_bf16_f32 v113, 0, v113
    v_cvt_pk_bf16_f32 v114, 0, v114
    v_cvt_pk_bf16_f32 v115, 0, v115
    v_add_f32 v108, v108, v109
    v_add_f32 v110, v110, v111
    v_add_f32 v112, v112, v113
    v_add_f32 v114, v114, v115
    v_add_f32 v108, v108, v110
    v_add_f32 v112, v112, v114
    v_add_f32 v118, v108, v112
    v_lshlrev_b32 v108, 16, v44
    v_and_b32 v109, s11, v44
    v_lshlrev_b32 v110, 16, v45
    v_and_b32 v111, s11, v45
    v_lshlrev_b32 v112, 16, v46
    v_and_b32 v113, s11, v46
    v_lshlrev_b32 v114, 16, v47
    v_and_b32 v115, s11, v47
    v_mul_f32 v108, v108, v100
    v_mul_f32 v109, v109, v101
    v_mul_f32 v110, v110, v102
    v_mul_f32 v111, v111, v103
    v_mul_f32 v112, v112, v104
    v_mul_f32 v113, v113, v105
    v_mul_f32 v114, v114, v106
    v_mul_f32 v115, v115, v107
    v_cvt_pk_bf16_f32 v108, 0, v108
    v_cvt_pk_bf16_f32 v109, 0, v109
    v_cvt_pk_bf16_f32 v110, 0, v110
    v_cvt_pk_bf16_f32 v111, 0, v111
    v_cvt_pk_bf16_f32 v112, 0, v112
    v_cvt_pk_bf16_f32 v113, 0, v113
    v_cvt_pk_bf16_f32 v114, 0, v114
    v_cvt_pk_bf16_f32 v115, 0, v115
    v_add_f32 v108, v108, v109
    v_add_f32 v110, v110, v111
    v_add_f32 v112, v112, v113
    v_add_f32 v114, v114, v115
    v_add_f32 v108, v108, v110
    v_add_f32 v112, v112, v114
    v_add_f32 v119, v108, v112
    s_waitcnt vmcnt(8)
    v_lshlrev_b32 v108, 16, v48
    v_and_b32 v109, s11, v48
    v_lshlrev_b32 v110, 16, v49
    v_and_b32 v111, s11, v49
    v_lshlrev_b32 v112, 16, v50
    v_and_b32 v113, s11, v50
    v_lshlrev_b32 v114, 16, v51
    v_and_b32 v115, s11, v51
    v_mul_f32 v108, v108, v100
    v_mul_f32 v109, v109, v101
    v_mul_f32 v110, v110, v102
    v_mul_f32 v111, v111, v103
    v_mul_f32 v112, v112, v104
    v_mul_f32 v113, v113, v105
    v_mul_f32 v114, v114, v106
    v_mul_f32 v115, v115, v107
    v_cvt_pk_bf16_f32 v108, 0, v108
    v_cvt_pk_bf16_f32 v109, 0, v109
    v_cvt_pk_bf16_f32 v110, 0, v110
    v_cvt_pk_bf16_f32 v111, 0, v111
    v_cvt_pk_bf16_f32 v112, 0, v112
    v_cvt_pk_bf16_f32 v113, 0, v113
    v_cvt_pk_bf16_f32 v114, 0, v114
    v_cvt_pk_bf16_f32 v115, 0, v115
    v_add_f32 v108, v108, v109
    v_add_f32 v110, v110, v111
    v_add_f32 v112, v112, v113
    v_add_f32 v114, v114, v115
    v_add_f32 v108, v108, v110
    v_add_f32 v112, v112, v114
    v_add_f32 v120, v108, v112
    v_lshlrev_b32 v108, 16, v52
    v_and_b32 v109, s11, v52
    v_lshlrev_b32 v110, 16, v53
    v_and_b32 v111, s11, v53
    v_lshlrev_b32 v112, 16, v54
    v_and_b32 v113, s11, v54
    v_lshlrev_b32 v114, 16, v55
    v_and_b32 v115, s11, v55
    v_mul_f32 v108, v108, v100
    v_mul_f32 v109, v109, v101
    v_mul_f32 v110, v110, v102
    v_mul_f32 v111, v111, v103
    v_mul_f32 v112, v112, v104
    v_mul_f32 v113, v113, v105
    v_mul_f32 v114, v114, v106
    v_mul_f32 v115, v115, v107
    v_cvt_pk_bf16_f32 v108, 0, v108
    v_cvt_pk_bf16_f32 v109, 0, v109
    v_cvt_pk_bf16_f32 v110, 0, v110
    v_cvt_pk_bf16_f32 v111, 0, v111
    v_cvt_pk_bf16_f32 v112, 0, v112
    v_cvt_pk_bf16_f32 v113, 0, v113
    v_cvt_pk_bf16_f32 v114, 0, v114
    v_cvt_pk_bf16_f32 v115, 0, v115
    v_add_f32 v108, v108, v109
    v_add_f32 v110, v110, v111
    v_add_f32 v112, v112, v113
    v_add_f32 v114, v114, v115
    v_add_f32 v108, v108, v110
    v_add_f32 v112, v112, v114
    v_add_f32 v121, v108, v112
    v_lshlrev_b32 v108, 16, v56
    v_and_b32 v109, s11, v56
    v_lshlrev_b32 v110, 16, v57
    v_and_b32 v111, s11, v57
    v_lshlrev_b32 v112, 16, v58
    v_and_b32 v113, s11, v58
    v_lshlrev_b32 v114, 16, v59
    v_and_b32 v115, s11, v59
    v_mul_f32 v108, v108, v100
    v_mul_f32 v109, v109, v101
    v_mul_f32 v110, v110, v102
    v_mul_f32 v111, v111, v103
    v_mul_f32 v112, v112, v104
    v_mul_f32 v113, v113, v105
    v_mul_f32 v114, v114, v106
    v_mul_f32 v115, v115, v107
    v_cvt_pk_bf16_f32 v108, 0, v108
    v_cvt_pk_bf16_f32 v109, 0, v109
    v_cvt_pk_bf16_f32 v110, 0, v110
    v_cvt_pk_bf16_f32 v111, 0, v111
    v_cvt_pk_bf16_f32 v112, 0, v112
    v_cvt_pk_bf16_f32 v113, 0, v113
    v_cvt_pk_bf16_f32 v114, 0, v114
    v_cvt_pk_bf16_f32 v115, 0, v115
    v_add_f32 v108, v108, v109
    v_add_f32 v110, v110, v111
    v_add_f32 v112, v112, v113
    v_add_f32 v114, v114, v115
    v_add_f32 v108, v108, v110
    v_add_f32 v112, v112, v114
    v_add_f32 v122, v108, v112
    v_lshlrev_b32 v108, 16, v60
    v_and_b32 v109, s11, v60
    v_lshlrev_b32 v110, 16, v61
    v_and_b32 v111, s11, v61
    v_lshlrev_b32 v112, 16, v62
    v_and_b32 v113, s11, v62
    v_lshlrev_b32 v114, 16, v63
    v_and_b32 v115, s11, v63
    v_mul_f32 v108, v108, v100
    v_mul_f32 v109, v109, v101
    v_mul_f32 v110, v110, v102
    v_mul_f32 v111, v111, v103
    v_mul_f32 v112, v112, v104
    v_mul_f32 v113, v113, v105
    v_mul_f32 v114, v114, v106
    v_mul_f32 v115, v115, v107
    v_cvt_pk_bf16_f32 v108, 0, v108
    v_cvt_pk_bf16_f32 v109, 0, v109
    v_cvt_pk_bf16_f32 v110, 0, v110
    v_cvt_pk_bf16_f32 v111, 0, v111
    v_cvt_pk_bf16_f32 v112, 0, v112
    v_cvt_pk_bf16_f32 v113, 0, v113
    v_cvt_pk_bf16_f32 v114, 0, v114
    v_cvt_pk_bf16_f32 v115, 0, v115
    v_add_f32 v108, v108, v109
    v_add_f32 v110, v110, v111
    v_add_f32 v112, v112, v113
    v_add_f32 v114, v114, v115
    v_add_f32 v108, v108, v110
    v_add_f32 v112, v112, v114
    v_add_f32 v123, v108, v112
    s_waitcnt vmcnt(4)
    v_lshlrev_b32 v108, 16, v64
    v_and_b32 v109, s11, v64
    v_lshlrev_b32 v110, 16, v65
    v_and_b32 v111, s11, v65
    v_lshlrev_b32 v112, 16, v66
    v_and_b32 v113, s11, v66
    v_lshlrev_b32 v114, 16, v67
    v_and_b32 v115, s11, v67
    v_mul_f32 v108, v108, v100
    v_mul_f32 v109, v109, v101
    v_mul_f32 v110, v110, v102
    v_mul_f32 v111, v111, v103
    v_mul_f32 v112, v112, v104
    v_mul_f32 v113, v113, v105
    v_mul_f32 v114, v114, v106
    v_mul_f32 v115, v115, v107
    v_cvt_pk_bf16_f32 v108, 0, v108
    v_cvt_pk_bf16_f32 v109, 0, v109
    v_cvt_pk_bf16_f32 v110, 0, v110
    v_cvt_pk_bf16_f32 v111, 0, v111
    v_cvt_pk_bf16_f32 v112, 0, v112
    v_cvt_pk_bf16_f32 v113, 0, v113
    v_cvt_pk_bf16_f32 v114, 0, v114
    v_cvt_pk_bf16_f32 v115, 0, v115
    v_add_f32 v108, v108, v109
    v_add_f32 v110, v110, v111
    v_add_f32 v112, v112, v113
    v_add_f32 v114, v114, v115
    v_add_f32 v108, v108, v110
    v_add_f32 v112, v112, v114
    v_add_f32 v124, v108, v112
    v_lshlrev_b32 v108, 16, v68
    v_and_b32 v109, s11, v68
    v_lshlrev_b32 v110, 16, v69
    v_and_b32 v111, s11, v69
    v_lshlrev_b32 v112, 16, v70
    v_and_b32 v113, s11, v70
    v_lshlrev_b32 v114, 16, v71
    v_and_b32 v115, s11, v71
    v_mul_f32 v108, v108, v100
    v_mul_f32 v109, v109, v101
    v_mul_f32 v110, v110, v102
    v_mul_f32 v111, v111, v103
    v_mul_f32 v112, v112, v104
    v_mul_f32 v113, v113, v105
    v_mul_f32 v114, v114, v106
    v_mul_f32 v115, v115, v107
    v_cvt_pk_bf16_f32 v108, 0, v108
    v_cvt_pk_bf16_f32 v109, 0, v109
    v_cvt_pk_bf16_f32 v110, 0, v110
    v_cvt_pk_bf16_f32 v111, 0, v111
    v_cvt_pk_bf16_f32 v112, 0, v112
    v_cvt_pk_bf16_f32 v113, 0, v113
    v_cvt_pk_bf16_f32 v114, 0, v114
    v_cvt_pk_bf16_f32 v115, 0, v115
    v_add_f32 v108, v108, v109
    v_add_f32 v110, v110, v111
    v_add_f32 v112, v112, v113
    v_add_f32 v114, v114, v115
    v_add_f32 v108, v108, v110
    v_add_f32 v112, v112, v114
    v_add_f32 v125, v108, v112
    v_lshlrev_b32 v108, 16, v72
    v_and_b32 v109, s11, v72
    v_lshlrev_b32 v110, 16, v73
    v_and_b32 v111, s11, v73
    v_lshlrev_b32 v112, 16, v74
    v_and_b32 v113, s11, v74
    v_lshlrev_b32 v114, 16, v75
    v_and_b32 v115, s11, v75
    v_mul_f32 v108, v108, v100
    v_mul_f32 v109, v109, v101
    v_mul_f32 v110, v110, v102
    v_mul_f32 v111, v111, v103
    v_mul_f32 v112, v112, v104
    v_mul_f32 v113, v113, v105
    v_mul_f32 v114, v114, v106
    v_mul_f32 v115, v115, v107
    v_cvt_pk_bf16_f32 v108, 0, v108
    v_cvt_pk_bf16_f32 v109, 0, v109
    v_cvt_pk_bf16_f32 v110, 0, v110
    v_cvt_pk_bf16_f32 v111, 0, v111
    v_cvt_pk_bf16_f32 v112, 0, v112
    v_cvt_pk_bf16_f32 v113, 0, v113
    v_cvt_pk_bf16_f32 v114, 0, v114
    v_cvt_pk_bf16_f32 v115, 0, v115
    v_add_f32 v108, v108, v109
    v_add_f32 v110, v110, v111
    v_add_f32 v112, v112, v113
    v_add_f32 v114, v114, v115
    v_add_f32 v108, v108, v110
    v_add_f32 v112, v112, v114
    v_add_f32 v126, v108, v112
    v_lshlrev_b32 v108, 16, v76
    v_and_b32 v109, s11, v76
    v_lshlrev_b32 v110, 16, v77
    v_and_b32 v111, s11, v77
    v_lshlrev_b32 v112, 16, v78
    v_and_b32 v113, s11, v78
    v_lshlrev_b32 v114, 16, v79
    v_and_b32 v115, s11, v79
    v_mul_f32 v108, v108, v100
    v_mul_f32 v109, v109, v101
    v_mul_f32 v110, v110, v102
    v_mul_f32 v111, v111, v103
    v_mul_f32 v112, v112, v104
    v_mul_f32 v113, v113, v105
    v_mul_f32 v114, v114, v106
    v_mul_f32 v115, v115, v107
    v_cvt_pk_bf16_f32 v108, 0, v108
    v_cvt_pk_bf16_f32 v109, 0, v109
    v_cvt_pk_bf16_f32 v110, 0, v110
    v_cvt_pk_bf16_f32 v111, 0, v111
    v_cvt_pk_bf16_f32 v112, 0, v112
    v_cvt_pk_bf16_f32 v113, 0, v113
    v_cvt_pk_bf16_f32 v114, 0, v114
    v_cvt_pk_bf16_f32 v115, 0, v115
    v_add_f32 v108, v108, v109
    v_add_f32 v110, v110, v111
    v_add_f32 v112, v112, v113
    v_add_f32 v114, v114, v115
    v_add_f32 v108, v108, v110
    v_add_f32 v112, v112, v114
    v_add_f32 v127, v108, v112
    s_waitcnt vmcnt(0)
    v_lshlrev_b32 v108, 16, v80
    v_and_b32 v109, s11, v80
    v_lshlrev_b32 v110, 16, v81
    v_and_b32 v111, s11, v81
    v_lshlrev_b32 v112, 16, v82
    v_and_b32 v113, s11, v82
    v_lshlrev_b32 v114, 16, v83
    v_and_b32 v115, s11, v83
    v_mul_f32 v108, v108, v100
    v_mul_f32 v109, v109, v101
    v_mul_f32 v110, v110, v102
    v_mul_f32 v111, v111, v103
    v_mul_f32 v112, v112, v104
    v_mul_f32 v113, v113, v105
    v_mul_f32 v114, v114, v106
    v_mul_f32 v115, v115, v107
    v_cvt_pk_bf16_f32 v108, 0, v108
    v_cvt_pk_bf16_f32 v109, 0, v109
    v_cvt_pk_bf16_f32 v110, 0, v110
    v_cvt_pk_bf16_f32 v111, 0, v111
    v_cvt_pk_bf16_f32 v112, 0, v112
    v_cvt_pk_bf16_f32 v113, 0, v113
    v_cvt_pk_bf16_f32 v114, 0, v114
    v_cvt_pk_bf16_f32 v115, 0, v115
    v_add_f32 v108, v108, v109
    v_add_f32 v110, v110, v111
    v_add_f32 v112, v112, v113
    v_add_f32 v114, v114, v115
    v_add_f32 v108, v108, v110
    v_add_f32 v112, v112, v114
    v_add_f32 v128, v108, v112
    v_lshlrev_b32 v108, 16, v84
    v_and_b32 v109, s11, v84
    v_lshlrev_b32 v110, 16, v85
    v_and_b32 v111, s11, v85
    v_lshlrev_b32 v112, 16, v86
    v_and_b32 v113, s11, v86
    v_lshlrev_b32 v114, 16, v87
    v_and_b32 v115, s11, v87
    v_mul_f32 v108, v108, v100
    v_mul_f32 v109, v109, v101
    v_mul_f32 v110, v110, v102
    v_mul_f32 v111, v111, v103
    v_mul_f32 v112, v112, v104
    v_mul_f32 v113, v113, v105
    v_mul_f32 v114, v114, v106
    v_mul_f32 v115, v115, v107
    v_cvt_pk_bf16_f32 v108, 0, v108
    v_cvt_pk_bf16_f32 v109, 0, v109
    v_cvt_pk_bf16_f32 v110, 0, v110
    v_cvt_pk_bf16_f32 v111, 0, v111
    v_cvt_pk_bf16_f32 v112, 0, v112
    v_cvt_pk_bf16_f32 v113, 0, v113
    v_cvt_pk_bf16_f32 v114, 0, v114
    v_cvt_pk_bf16_f32 v115, 0, v115
    v_add_f32 v108, v108, v109
    v_add_f32 v110, v110, v111
    v_add_f32 v112, v112, v113
    v_add_f32 v114, v114, v115
    v_add_f32 v108, v108, v110
    v_add_f32 v112, v112, v114
    v_add_f32 v129, v108, v112
    v_lshlrev_b32 v108, 16, v88
    v_and_b32 v109, s11, v88
    v_lshlrev_b32 v110, 16, v89
    v_and_b32 v111, s11, v89
    v_lshlrev_b32 v112, 16, v90
    v_and_b32 v113, s11, v90
    v_lshlrev_b32 v114, 16, v91
    v_and_b32 v115, s11, v91
    v_mul_f32 v108, v108, v100
    v_mul_f32 v109, v109, v101
    v_mul_f32 v110, v110, v102
    v_mul_f32 v111, v111, v103
    v_mul_f32 v112, v112, v104
    v_mul_f32 v113, v113, v105
    v_mul_f32 v114, v114, v106
    v_mul_f32 v115, v115, v107
    v_cvt_pk_bf16_f32 v108, 0, v108
    v_cvt_pk_bf16_f32 v109, 0, v109
    v_cvt_pk_bf16_f32 v110, 0, v110
    v_cvt_pk_bf16_f32 v111, 0, v111
    v_cvt_pk_bf16_f32 v112, 0, v112
    v_cvt_pk_bf16_f32 v113, 0, v113
    v_cvt_pk_bf16_f32 v114, 0, v114
    v_cvt_pk_bf16_f32 v115, 0, v115
    v_add_f32 v108, v108, v109
    v_add_f32 v110, v110, v111
    v_add_f32 v112, v112, v113
    v_add_f32 v114, v114, v115
    v_add_f32 v108, v108, v110
    v_add_f32 v112, v112, v114
    v_add_f32 v130, v108, v112
    v_lshlrev_b32 v108, 16, v92
    v_and_b32 v109, s11, v92
    v_lshlrev_b32 v110, 16, v93
    v_and_b32 v111, s11, v93
    v_lshlrev_b32 v112, 16, v94
    v_and_b32 v113, s11, v94
    v_lshlrev_b32 v114, 16, v95
    v_and_b32 v115, s11, v95
    v_mul_f32 v108, v108, v100
    v_mul_f32 v109, v109, v101
    v_mul_f32 v110, v110, v102
    v_mul_f32 v111, v111, v103
    v_mul_f32 v112, v112, v104
    v_mul_f32 v113, v113, v105
    v_mul_f32 v114, v114, v106
    v_mul_f32 v115, v115, v107
    v_cvt_pk_bf16_f32 v108, 0, v108
    v_cvt_pk_bf16_f32 v109, 0, v109
    v_cvt_pk_bf16_f32 v110, 0, v110
    v_cvt_pk_bf16_f32 v111, 0, v111
    v_cvt_pk_bf16_f32 v112, 0, v112
    v_cvt_pk_bf16_f32 v113, 0, v113
    v_cvt_pk_bf16_f32 v114, 0, v114
    v_cvt_pk_bf16_f32 v115, 0, v115
    v_add_f32 v108, v108, v109
    v_add_f32 v110, v110, v111
    v_add_f32 v112, v112, v113
    v_add_f32 v114, v114, v115
    v_add_f32 v108, v108, v110
    v_add_f32 v112, v112, v114
    v_add_f32 v131, v108, v112
    v_add_f32_dpp v116, v116, v116 quad_perm:[1,0,3,2] row_mask:0xf bank_mask:0xf
    v_add_f32_dpp v117, v117, v117 quad_perm:[1,0,3,2] row_mask:0xf bank_mask:0xf
    v_add_f32_dpp v118, v118, v118 quad_perm:[1,0,3,2] row_mask:0xf bank_mask:0xf
    v_add_f32_dpp v119, v119, v119 quad_perm:[1,0,3,2] row_mask:0xf bank_mask:0xf
    v_add_f32_dpp v120, v120, v120 quad_perm:[1,0,3,2] row_mask:0xf bank_mask:0xf
    v_add_f32_dpp v121, v121, v121 quad_perm:[1,0,3,2] row_mask:0xf bank_mask:0xf
    v_add_f32_dpp v122, v122, v122 quad_perm:[1,0,3,2] row_mask:0xf bank_mask:0xf
    v_add_f32_dpp v123, v123, v123 quad_perm:[1,0,3,2] row_mask:0xf bank_mask:0xf
    v_add_f32_dpp v124, v124, v124 quad_perm:[1,0,3,2] row_mask:0xf bank_mask:0xf
    v_add_f32_dpp v125, v125, v125 quad_perm:[1,0,3,2] row_mask:0xf bank_mask:0xf
    v_add_f32_dpp v126, v126, v126 quad_perm:[1,0,3,2] row_mask:0xf bank_mask:0xf
    v_add_f32_dpp v127, v127, v127 quad_perm:[1,0,3,2] row_mask:0xf bank_mask:0xf
    v_add_f32_dpp v128, v128, v128 quad_perm:[1,0,3,2] row_mask:0xf bank_mask:0xf
    v_add_f32_dpp v129, v129, v129 quad_perm:[1,0,3,2] row_mask:0xf bank_mask:0xf
    v_add_f32_dpp v130, v130, v130 quad_perm:[1,0,3,2] row_mask:0xf bank_mask:0xf
    v_add_f32_dpp v131, v131, v131 quad_perm:[1,0,3,2] row_mask:0xf bank_mask:0xf
    v_add_f32_dpp v116, v116, v116 quad_perm:[2,3,0,1] row_mask:0xf bank_mask:0xf
    v_add_f32_dpp v117, v117, v117 quad_perm:[2,3,0,1] row_mask:0xf bank_mask:0xf
    v_add_f32_dpp v118, v118, v118 quad_perm:[2,3,0,1] row_mask:0xf bank_mask:0xf
    v_add_f32_dpp v119, v119, v119 quad_perm:[2,3,0,1] row_mask:0xf bank_mask:0xf
    v_add_f32_dpp v120, v120, v120 quad_perm:[2,3,0,1] row_mask:0xf bank_mask:0xf
    v_add_f32_dpp v121, v121, v121 quad_perm:[2,3,0,1] row_mask:0xf bank_mask:0xf
    v_add_f32_dpp v122, v122, v122 quad_perm:[2,3,0,1] row_mask:0xf bank_mask:0xf
    v_add_f32_dpp v123, v123, v123 quad_perm:[2,3,0,1] row_mask:0xf bank_mask:0xf
    v_add_f32_dpp v124, v124, v124 quad_perm:[2,3,0,1] row_mask:0xf bank_mask:0xf
    v_add_f32_dpp v125, v125, v125 quad_perm:[2,3,0,1] row_mask:0xf bank_mask:0xf
    v_add_f32_dpp v126, v126, v126 quad_perm:[2,3,0,1] row_mask:0xf bank_mask:0xf
    v_add_f32_dpp v127, v127, v127 quad_perm:[2,3,0,1] row_mask:0xf bank_mask:0xf
    v_add_f32_dpp v128, v128, v128 quad_perm:[2,3,0,1] row_mask:0xf bank_mask:0xf
    v_add_f32_dpp v129, v129, v129 quad_perm:[2,3,0,1] row_mask:0xf bank_mask:0xf
    v_add_f32_dpp v130, v130, v130 quad_perm:[2,3,0,1] row_mask:0xf bank_mask:0xf
    v_add_f32_dpp v131, v131, v131 quad_perm:[2,3,0,1] row_mask:0xf bank_mask:0xf
    v_add_f32_dpp v116, v116, v116 row_half_mirror row_mask:0xf bank_mask:0xf
    v_add_f32_dpp v117, v117, v117 row_half_mirror row_mask:0xf bank_mask:0xf
    v_add_f32_dpp v118, v118, v118 row_half_mirror row_mask:0xf bank_mask:0xf
    v_add_f32_dpp v119, v119, v119 row_half_mirror row_mask:0xf bank_mask:0xf
    v_add_f32_dpp v120, v120, v120 row_half_mirror row_mask:0xf bank_mask:0xf
    v_add_f32_dpp v121, v121, v121 row_half_mirror row_mask:0xf bank_mask:0xf
    v_add_f32_dpp v122, v122, v122 row_half_mirror row_mask:0xf bank_mask:0xf
    v_add_f32_dpp v123, v123, v123 row_half_mirror row_mask:0xf bank_mask:0xf
    v_add_f32_dpp v124, v124, v124 row_half_mirror row_mask:0xf bank_mask:0xf
    v_add_f32_dpp v125, v125, v125 row_half_mirror row_mask:0xf bank_mask:0xf
    v_add_f32_dpp v126, v126, v126 row_half_mirror row_mask:0xf bank_mask:0xf
    v_add_f32_dpp v127, v127, v127 row_half_mirror row_mask:0xf bank_mask:0xf
    v_add_f32_dpp v128, v128, v128 row_half_mirror row_mask:0xf bank_mask:0xf
    v_add_f32_dpp v129, v129, v129 row_half_mirror row_mask:0xf bank_mask:0xf
    v_add_f32_dpp v130, v130, v130 row_half_mirror row_mask:0xf bank_mask:0xf
    v_add_f32_dpp v131, v131, v131 row_half_mirror row_mask:0xf bank_mask:0xf
    v_add_f32_dpp v116, v116, v116 row_mirror row_mask:0xf bank_mask:0xf
    v_add_f32_dpp v117, v117, v117 row_mirror row_mask:0xf bank_mask:0xf
    v_add_f32_dpp v118, v118, v118 row_mirror row_mask:0xf bank_mask:0xf
    v_add_f32_dpp v119, v119, v119 row_mirror row_mask:0xf bank_mask:0xf
    v_add_f32_dpp v120, v120, v120 row_mirror row_mask:0xf bank_mask:0xf
    v_add_f32_dpp v121, v121, v121 row_mirror row_mask:0xf bank_mask:0xf
    v_add_f32_dpp v122, v122, v122 row_mirror row_mask:0xf bank_mask:0xf
    v_add_f32_dpp v123, v123, v123 row_mirror row_mask:0xf bank_mask:0xf
    v_add_f32_dpp v124, v124, v124 row_mirror row_mask:0xf bank_mask:0xf
    v_add_f32_dpp v125, v125, v125 row_mirror row_mask:0xf bank_mask:0xf
    v_add_f32_dpp v126, v126, v126 row_mirror row_mask:0xf bank_mask:0xf
    v_add_f32_dpp v127, v127, v127 row_mirror row_mask:0xf bank_mask:0xf
    v_add_f32_dpp v128, v128, v128 row_mirror row_mask:0xf bank_mask:0xf
    v_add_f32_dpp v129, v129, v129 row_mirror row_mask:0xf bank_mask:0xf
    v_add_f32_dpp v130, v130, v130 row_mirror row_mask:0xf bank_mask:0xf
    v_add_f32_dpp v131, v131, v131 row_mirror row_mask:0xf bank_mask:0xf
    v_and_b32 v1, 15, v0
    v_cmp_eq_u32 vcc, 1, v1
    s_nop 1
    v_cndmask_b32 v116, v116, v117, vcc
    v_cmp_eq_u32 vcc, 2, v1
    s_nop 1
    v_cndmask_b32 v116, v116, v118, vcc
    v_cmp_eq_u32 vcc, 3, v1
    s_nop 1
    v_cndmask_b32 v116, v116, v119, vcc
    v_cmp_eq_u32 vcc, 4, v1
    s_nop 1
    v_cndmask_b32 v116, v116, v120, vcc
    v_cmp_eq_u32 vcc, 5, v1
    s_nop 1
    v_cndmask_b32 v116, v116, v121, vcc
    v_cmp_eq_u32 vcc, 6, v1
    s_nop 1
    v_cndmask_b32 v116, v116, v122, vcc
    v_cmp_eq_u32 vcc, 7, v1
    s_nop 1
    v_cndmask_b32 v116, v116, v123, vcc
    v_cmp_eq_u32 vcc, 8, v1
    s_nop 1
    v_cndmask_b32 v116, v116, v124, vcc
    v_cmp_eq_u32 vcc, 9, v1
    s_nop 1
    v_cndmask_b32 v116, v116, v125, vcc
    v_cmp_eq_u32 vcc, 10, v1
    s_nop 1
    v_cndmask_b32 v116, v116, v126, vcc
    v_cmp_eq_u32 vcc, 11, v1
    s_nop 1
    v_cndmask_b32 v116, v116, v127, vcc
    v_cmp_eq_u32 vcc, 12, v1
    s_nop 1
    v_cndmask_b32 v116, v116, v128, vcc
    v_cmp_eq_u32 vcc, 13, v1
    s_nop 1
    v_cndmask_b32 v116, v116, v129, vcc
    v_cmp_eq_u32 vcc, 14, v1
    s_nop 1
    v_cndmask_b32 v116, v116, v130, vcc
    v_cmp_eq_u32 vcc, 15, v1
    s_nop 1
    v_cndmask_b32 v116, v116, v131, vcc
    v_mov_b32 v117, v116
    s_nop 1
    v_permlane32_swap_b32 v116, v117
    v_add_f32 v116, v116, v117
    v_mov_b32 v117, v116
    s_nop 1
    v_permlane16_swap_b32 v116, v117
    v_add_f32 v116, v116, v117
    v_cvt_pk_bf16_f32 v116, 0, v116
    v_mul_f32 v116, 0xbfb8aa3b, v116
    v_exp_f32 v116, v116
    s_nop 0
    v_add_f32 v116, 1.0, v116
    v_rcp_f32 v116, v116
    s_nop 0
    v_cvt_pk_bf16_f32 v116, 0, v116
    v_lshlrev_b32 v1, 2, v0
    v_cmp_gt_u32 vcc, 16, v0
    v_mov_b32 v3, 0x7fffffff
    s_nop 0
    v_cndmask_b32 v132, v3, v1, vcc
    buffer_store_dword v116, v132, s[12:15], s63 offen sc1
    s_lshl_b32 s64, s64, 7
    s_add_u32 s64, s64, 14811136
    s_waitcnt vmcnt(0) lgkmcnt(0)
    buffer_store_dwordx2 v[16:17], v19, s[12:15], s64 offen sc1
Lm_rw:
    s_mov_b32 s10, 0
Lm_rdy:
    ds_read_b32 v2, v27 offset:6432
    s_waitcnt lgkmcnt(0)
    v_cmp_gt_u32 vcc, 1, v2
    s_cbranch_vccz Lm_rdy_ok
    s_sleep 1
    s_add_u32 s10, s10, 1
    s_cmp_lt_u32 s10, 300000
    s_cbranch_scc1 Lm_rdy
Lm_rdy_ok:
    ds_read_b128 v[32:35], v20 offset:3584
    ds_read_b64 v[96:97], v21 offset:0
    ds_read_b64 v[98:99], v21 offset:8
    ds_read_b128 v[36:39], v20 offset:3072
    ds_read_b64 v[100:101], v21 offset:512
    ds_read_b64 v[102:103], v21 offset:520
    ds_read_b128 v[40:43], v20 offset:2560
    ds_read_b64 v[104:105], v21 offset:1024
    ds_read_b64 v[106:107], v21 offset:1032
    ds_read_b128 v[44:47], v20 offset:2048
    ds_read_b64 v[108:109], v21 offset:1536
    ds_read_b64 v[110:111], v21 offset:1544
    ds_read_b128 v[48:51], v20 offset:1536
    ds_read_b64 v[112:113], v21 offset:2048
    ds_read_b64 v[114:115], v21 offset:2056
    ds_read_b128 v[52:55], v20 offset:1024
    ds_read_b64 v[116:117], v21 offset:2560
    ds_read_b64 v[118:119], v21 offset:2568
    ds_read_b128 v[56:59], v20 offset:512
    ds_read_b64 v[120:121], v21 offset:3072
    ds_read_b64 v[122:123], v21 offset:3080
    ds_read_b128 v[60:63], v20 offset:0
    ds_read_b64 v[124:125], v21 offset:3584
    ds_read_b64 v[126:127], v21 offset:3592
    s_waitcnt lgkmcnt(15)
    v_mfma_f32_16x16x32_bf16 v[160:163], v[32:35], v[96:99], 0
    v_mfma_f32_16x16x32_bf16 v[164:167], v[32:35], v[100:103], 0
    v_mfma_f32_16x16x32_bf16 v[164:167], v[36:39], v[96:99], v[164:167]
    v_mfma_f32_16x16x32_bf16 v[168:171], v[36:39], v[100:103], 0
    v_mfma_f32_16x16x32_bf16 v[168:171], v[32:35], v[104:107], v[168:171]
    ds_read_b128 v[64:67], v20 offset:3648
    v_mfma_f32_16x16x32_bf16 v[172:175], v[36:39], v[104:107], 0
    ds_read_b64 v[128:129], v21 offset:64
    v_mfma_f32_16x16x32_bf16 v[168:171], v[40:43], v[96:99], v[168:171]
    ds_read_b64 v[130:131], v21 offset:72
    v_mfma_f32_16x16x32_bf16 v[172:175], v[40:43], v[100:103], v[172:175]
    ds_read_b128 v[68:71], v20 offset:3136
    v_mfma_f32_16x16x32_bf16 v[176:179], v[40:43], v[104:107], 0
    ds_read_b64 v[132:133], v21 offset:576
    s_waitcnt lgkmcnt(15)
    v_mfma_f32_16x16x32_bf16 v[172:175], v[32:35], v[108:111], v[172:175]
    ds_read_b64 v[134:135], v21 offset:584
    v_mfma_f32_16x16x32_bf16 v[176:179], v[36:39], v[108:111], v[176:179]
    ds_read_b128 v[72:75], v20 offset:2624
    v_mfma_f32_16x16x32_bf16 v[180:183], v[40:43], v[108:111], 0
    ds_read_b64 v[136:137], v21 offset:1088
    v_mfma_f32_16x16x32_bf16 v[172:175], v[44:47], v[96:99], v[172:175]
    ds_read_b64 v[138:139], v21 offset:1096
    v_mfma_f32_16x16x32_bf16 v[176:179], v[44:47], v[100:103], v[176:179]
    ds_read_b128 v[76:79], v20 offset:2112
    v_mfma_f32_16x16x32_bf16 v[180:183], v[44:47], v[104:107], v[180:183]
    ds_read_b64 v[140:141], v21 offset:1600
    v_mfma_f32_16x16x32_bf16 v[184:187], v[44:47], v[108:111], 0
    ds_read_b64 v[142:143], v21 offset:1608
    s_waitcnt lgkmcnt(15)
    v_mfma_f32_16x16x32_bf16 v[176:179], v[32:35], v[112:115], v[176:179]
    ds_read_b128 v[80:83], v20 offset:1600
    v_mfma_f32_16x16x32_bf16 v[180:183], v[36:39], v[112:115], v[180:183]
    ds_read_b64 v[144:145], v21 offset:2112
    v_mfma_f32_16x16x32_bf16 v[184:187], v[40:43], v[112:115], v[184:187]
    ds_read_b64 v[146:147], v21 offset:2120
    v_mfma_f32_16x16x32_bf16 v[188:191], v[44:47], v[112:115], 0
    ds_read_b128 v[84:87], v20 offset:1088
    v_mfma_f32_16x16x32_bf16 v[176:179], v[48:51], v[96:99], v[176:179]
    ds_read_b64 v[148:149], v21 offset:2624
    v_mfma_f32_16x16x32_bf16 v[180:183], v[48:51], v[100:103], v[180:183]
    ds_read_b64 v[150:151], v21 offset:2632
    v_mfma_f32_16x16x32_bf16 v[184:187], v[48:51], v[104:107], v[184:187]
    ds_read_b128 v[88:91], v20 offset:576
    v_mfma_f32_16x16x32_bf16 v[188:191], v[48:51], v[108:111], v[188:191]
    ds_read_b64 v[152:153], v21 offset:3136
    s_waitcnt vmcnt(0)
    buffer_store_dwordx2 v[16:17], v19, s[12:15], s52 offen sc1
    s_setprio 2
    v_mfma_f32_16x16x32_bf16 v[180:183], v[32:35], v[116:119], v[180:183]
    ds_read_b64 v[154:155], v21 offset:3144
    s_mov_b64 exec, 1
    ds_write_b32 v25, v26 offset:6464
    s_mov_b64 exec, -1
    v_mfma_f32_16x16x32_bf16 v[184:187], v[36:39], v[116:119], v[184:187]
    ds_read_b128 v[92:95], v20 offset:64
    v_mfma_f32_16x16x32_bf16 v[188:191], v[40:43], v[116:119], v[188:191]
    ds_read_b64 v[156:157], v21 offset:3648
    v_mfma_f32_16x16x32_bf16 v[180:183], v[52:55], v[96:99], v[180:183]
    ds_read_b64 v[158:159], v21 offset:3656
    v_mfma_f32_16x16x32_bf16 v[184:187], v[52:55], v[100:103], v[184:187]
    v_mfma_f32_16x16x32_bf16 v[188:191], v[52:55], v[104:107], v[188:191]
    v_mfma_f32_16x16x32_bf16 v[184:187], v[32:35], v[120:123], v[184:187]
    v_mfma_f32_16x16x32_bf16 v[188:191], v[36:39], v[120:123], v[188:191]
    v_mfma_f32_16x16x32_bf16 v[184:187], v[56:59], v[96:99], v[184:187]
    v_mfma_f32_16x16x32_bf16 v[188:191], v[56:59], v[100:103], v[188:191]
    s_waitcnt lgkmcnt(15)
    v_mfma_f32_16x16x32_bf16 v[188:191], v[32:35], v[124:127], v[188:191]
    v_mfma_f32_16x16x32_bf16 v[188:191], v[60:63], v[96:99], v[188:191]
    v_mfma_f32_16x16x32_bf16 v[160:163], v[64:67], v[128:131], v[160:163]
    v_mfma_f32_16x16x32_bf16 v[164:167], v[64:67], v[132:135], v[164:167]
    v_mfma_f32_16x16x32_bf16 v[164:167], v[68:71], v[128:131], v[164:167]
    v_mfma_f32_16x16x32_bf16 v[168:171], v[68:71], v[132:135], v[168:171]
    v_mfma_f32_16x16x32_bf16 v[168:171], v[64:67], v[136:139], v[168:171]
    ds_read_b128 v[32:35], v20 offset:3712
    v_mfma_f32_16x16x32_bf16 v[172:175], v[68:71], v[136:139], v[172:175]
    ds_read_b64 v[96:97], v21 offset:128
    v_mfma_f32_16x16x32_bf16 v[168:171], v[72:75], v[128:131], v[168:171]
    ds_read_b64 v[98:99], v21 offset:136
    v_mfma_f32_16x16x32_bf16 v[172:175], v[72:75], v[132:135], v[172:175]
    ds_read_b128 v[36:39], v20 offset:3200
    v_mfma_f32_16x16x32_bf16 v[176:179], v[72:75], v[136:139], v[176:179]
    ds_read_b64 v[100:101], v21 offset:640
    s_waitcnt lgkmcnt(15)
    v_mfma_f32_16x16x32_bf16 v[172:175], v[64:67], v[140:143], v[172:175]
    ds_read_b64 v[102:103], v21 offset:648
    v_mfma_f32_16x16x32_bf16 v[176:179], v[68:71], v[140:143], v[176:179]
    ds_read_b128 v[40:43], v20 offset:2688
    v_mfma_f32_16x16x32_bf16 v[180:183], v[72:75], v[140:143], v[180:183]
    ds_read_b64 v[104:105], v21 offset:1152
    v_mfma_f32_16x16x32_bf16 v[172:175], v[76:79], v[128:131], v[172:175]
    ds_read_b64 v[106:107], v21 offset:1160
    v_mfma_f32_16x16x32_bf16 v[176:179], v[76:79], v[132:135], v[176:179]
    ds_read_b128 v[44:47], v20 offset:2176
    v_mfma_f32_16x16x32_bf16 v[180:183], v[76:79], v[136:139], v[180:183]
    ds_read_b64 v[108:109], v21 offset:1664
    v_mfma_f32_16x16x32_bf16 v[184:187], v[76:79], v[140:143], v[184:187]
    ds_read_b64 v[110:111], v21 offset:1672
    v_mfma_f32_16x16x32_bf16 v[176:179], v[64:67], v[144:147], v[176:179]
    ds_read_b128 v[48:51], v20 offset:1664
    v_mfma_f32_16x16x32_bf16 v[180:183], v[68:71], v[144:147], v[180:183]
    ds_read_b64 v[112:113], v21 offset:2176
    v_mfma_f32_16x16x32_bf16 v[184:187], v[72:75], v[144:147], v[184:187]
    ds_read_b64 v[114:115], v21 offset:2184
    v_mfma_f32_16x16x32_bf16 v[188:191], v[76:79], v[144:147], v[188:191]
    ds_read_b128 v[52:55], v20 offset:1152
    v_mfma_f32_16x16x32_bf16 v[176:179], v[80:83], v[128:131], v[176:179]
    ds_read_b64 v[116:117], v21 offset:2688
    v_mfma_f32_16x16x32_bf16 v[180:183], v[80:83], v[132:135], v[180:183]
    ds_read_b64 v[118:119], v21 offset:2696
    v_mfma_f32_16x16x32_bf16 v[184:187], v[80:83], v[136:139], v[184:187]
    ds_read_b128 v[56:59], v20 offset:640
    v_mfma_f32_16x16x32_bf16 v[188:191], v[80:83], v[140:143], v[188:191]
    ds_read_b64 v[120:121], v21 offset:3200
    s_waitcnt lgkmcnt(15)
    v_mfma_f32_16x16x32_bf16 v[180:183], v[64:67], v[148:151], v[180:183]
    ds_read_b64 v[122:123], v21 offset:3208
    v_mfma_f32_16x16x32_bf16 v[184:187], v[68:71], v[148:151], v[184:187]
    ds_read_b128 v[60:63], v20 offset:128
    v_mfma_f32_16x16x32_bf16 v[188:191], v[72:75], v[148:151], v[188:191]
    ds_read_b64 v[124:125], v21 offset:3712
    v_mfma_f32_16x16x32_bf16 v[180:183], v[84:87], v[128:131], v[180:183]
    ds_read_b64 v[126:127], v21 offset:3720
    v_mfma_f32_16x16x32_bf16 v[184:187], v[84:87], v[132:135], v[184:187]
    v_mfma_f32_16x16x32_bf16 v[188:191], v[84:87], v[136:139], v[188:191]
    v_mfma_f32_16x16x32_bf16 v[184:187], v[64:67], v[152:155], v[184:187]
    v_mfma_f32_16x16x32_bf16 v[188:191], v[68:71], v[152:155], v[188:191]
    v_mfma_f32_16x16x32_bf16 v[184:187], v[88:91], v[128:131], v[184:187]
    v_mfma_f32_16x16x32_bf16 v[188:191], v[88:91], v[132:135], v[188:191]
    v_mfma_f32_16x16x32_bf16 v[188:191], v[64:67], v[156:159], v[188:191]
    v_mfma_f32_16x16x32_bf16 v[188:191], v[92:95], v[128:131], v[188:191]
    v_mfma_f32_16x16x32_bf16 v[160:163], v[32:35], v[96:99], v[160:163]
    s_waitcnt lgkmcnt(15)
    v_mfma_f32_16x16x32_bf16 v[164:167], v[32:35], v[100:103], v[164:167]
    v_mfma_f32_16x16x32_bf16 v[164:167], v[36:39], v[96:99], v[164:167]
    v_mfma_f32_16x16x32_bf16 v[168:171], v[36:39], v[100:103], v[168:171]
    v_mfma_f32_16x16x32_bf16 v[168:171], v[32:35], v[104:107], v[168:171]
    ds_read_b128 v[64:67], v20 offset:3776
    v_mfma_f32_16x16x32_bf16 v[172:175], v[36:39], v[104:107], v[172:175]
    ds_read_b64 v[128:129], v21 offset:192
    v_mfma_f32_16x16x32_bf16 v[168:171], v[40:43], v[96:99], v[168:171]
    ds_read_b64 v[130:131], v21 offset:200
    v_mfma_f32_16x16x32_bf16 v[172:175], v[40:43], v[100:103], v[172:175]
    ds_read_b128 v[68:71], v20 offset:3264
    v_mfma_f32_16x16x32_bf16 v[176:179], v[40:43], v[104:107], v[176:179]
    ds_read_b64 v[132:133], v21 offset:704
    s_waitcnt lgkmcnt(15)
    v_mfma_f32_16x16x32_bf16 v[172:175], v[32:35], v[108:111], v[172:175]
    ds_read_b64 v[134:135], v21 offset:712
    v_mfma_f32_16x16x32_bf16 v[176:179], v[36:39], v[108:111], v[176:179]
    ds_read_b128 v[72:75], v20 offset:2752
    v_mfma_f32_16x16x32_bf16 v[180:183], v[40:43], v[108:111], v[180:183]
    ds_read_b64 v[136:137], v21 offset:1216
    v_mfma_f32_16x16x32_bf16 v[172:175], v[44:47], v[96:99], v[172:175]
    ds_read_b64 v[138:139], v21 offset:1224
    v_mfma_f32_16x16x32_bf16 v[176:179], v[44:47], v[100:103], v[176:179]
    ds_read_b128 v[76:79], v20 offset:2240
    v_mfma_f32_16x16x32_bf16 v[180:183], v[44:47], v[104:107], v[180:183]
    ds_read_b64 v[140:141], v21 offset:1728
    v_mfma_f32_16x16x32_bf16 v[184:187], v[44:47], v[108:111], v[184:187]
    ds_read_b64 v[142:143], v21 offset:1736
    s_waitcnt lgkmcnt(15)
    v_mfma_f32_16x16x32_bf16 v[176:179], v[32:35], v[112:115], v[176:179]
    ds_read_b128 v[80:83], v20 offset:1728
    v_mfma_f32_16x16x32_bf16 v[180:183], v[36:39], v[112:115], v[180:183]
    ds_read_b64 v[144:145], v21 offset:2240
    v_mfma_f32_16x16x32_bf16 v[184:187], v[40:43], v[112:115], v[184:187]
    ds_read_b64 v[146:147], v21 offset:2248
    v_mfma_f32_16x16x32_bf16 v[188:191], v[44:47], v[112:115], v[188:191]
    ds_read_b128 v[84:87], v20 offset:1216
    v_mfma_f32_16x16x32_bf16 v[176:179], v[48:51], v[96:99], v[176:179]
    ds_read_b64 v[148:149], v21 offset:2752
    v_mfma_f32_16x16x32_bf16 v[180:183], v[48:51], v[100:103], v[180:183]
    ds_read_b64 v[150:151], v21 offset:2760
    v_mfma_f32_16x16x32_bf16 v[184:187], v[48:51], v[104:107], v[184:187]
    ds_read_b128 v[88:91], v20 offset:704
    v_mfma_f32_16x16x32_bf16 v[188:191], v[48:51], v[108:111], v[188:191]
    ds_read_b64 v[152:153], v21 offset:3264
    v_mfma_f32_16x16x32_bf16 v[180:183], v[32:35], v[116:119], v[180:183]
    ds_read_b64 v[154:155], v21 offset:3272
    v_mfma_f32_16x16x32_bf16 v[184:187], v[36:39], v[116:119], v[184:187]
    ds_read_b128 v[92:95], v20 offset:192
    v_mfma_f32_16x16x32_bf16 v[188:191], v[40:43], v[116:119], v[188:191]
    ds_read_b64 v[156:157], v21 offset:3776
    v_mfma_f32_16x16x32_bf16 v[180:183], v[52:55], v[96:99], v[180:183]
    ds_read_b64 v[158:159], v21 offset:3784
    v_mfma_f32_16x16x32_bf16 v[184:187], v[52:55], v[100:103], v[184:187]
    v_mfma_f32_16x16x32_bf16 v[188:191], v[52:55], v[104:107], v[188:191]
    v_mfma_f32_16x16x32_bf16 v[184:187], v[32:35], v[120:123], v[184:187]
    v_mfma_f32_16x16x32_bf16 v[188:191], v[36:39], v[120:123], v[188:191]
    v_mfma_f32_16x16x32_bf16 v[184:187], v[56:59], v[96:99], v[184:187]
    v_mfma_f32_16x16x32_bf16 v[188:191], v[56:59], v[100:103], v[188:191]
    s_waitcnt lgkmcnt(15)
    v_mfma_f32_16x16x32_bf16 v[188:191], v[32:35], v[124:127], v[188:191]
    v_mfma_f32_16x16x32_bf16 v[188:191], v[60:63], v[96:99], v[188:191]
    v_mfma_f32_16x16x32_bf16 v[160:163], v[64:67], v[128:131], v[160:163]
    v_mfma_f32_16x16x32_bf16 v[164:167], v[64:67], v[132:135], v[164:167]
    v_mfma_f32_16x16x32_bf16 v[164:167], v[68:71], v[128:131], v[164:167]
    v_mfma_f32_16x16x32_bf16 v[168:171], v[68:71], v[132:135], v[168:171]
    v_mfma_f32_16x16x32_bf16 v[168:171], v[64:67], v[136:139], v[168:171]
    v_mfma_f32_16x16x32_bf16 v[172:175], v[68:71], v[136:139], v[172:175]
    v_mfma_f32_16x16x32_bf16 v[168:171], v[72:75], v[128:131], v[168:171]
    v_mfma_f32_16x16x32_bf16 v[172:175], v[72:75], v[132:135], v[172:175]
    v_mfma_f32_16x16x32_bf16 v[176:179], v[72:75], v[136:139], v[176:179]
    s_waitcnt lgkmcnt(12)
    v_mfma_f32_16x16x32_bf16 v[172:175], v[64:67], v[140:143], v[172:175]
    v_mfma_f32_16x16x32_bf16 v[176:179], v[68:71], v[140:143], v[176:179]
    v_mfma_f32_16x16x32_bf16 v[180:183], v[72:75], v[140:143], v[180:183]
    v_mfma_f32_16x16x32_bf16 v[172:175], v[76:79], v[128:131], v[172:175]
    v_mfma_f32_16x16x32_bf16 v[176:179], v[76:79], v[132:135], v[176:179]
    v_mfma_f32_16x16x32_bf16 v[180:183], v[76:79], v[136:139], v[180:183]
    v_mfma_f32_16x16x32_bf16 v[184:187], v[76:79], v[140:143], v[184:187]
    s_waitcnt lgkmcnt(9)
    v_mfma_f32_16x16x32_bf16 v[176:179], v[64:67], v[144:147], v[176:179]
    v_mfma_f32_16x16x32_bf16 v[180:183], v[68:71], v[144:147], v[180:183]
    v_mfma_f32_16x16x32_bf16 v[184:187], v[72:75], v[144:147], v[184:187]
    v_mfma_f32_16x16x32_bf16 v[188:191], v[76:79], v[144:147], v[188:191]
    v_mfma_f32_16x16x32_bf16 v[176:179], v[80:83], v[128:131], v[176:179]
    v_mfma_f32_16x16x32_bf16 v[180:183], v[80:83], v[132:135], v[180:183]
    v_mfma_f32_16x16x32_bf16 v[184:187], v[80:83], v[136:139], v[184:187]
    v_mfma_f32_16x16x32_bf16 v[188:191], v[80:83], v[140:143], v[188:191]
    s_waitcnt lgkmcnt(6)
    v_mfma_f32_16x16x32_bf16 v[180:183], v[64:67], v[148:151], v[180:183]
    v_mfma_f32_16x16x32_bf16 v[184:187], v[68:71], v[148:151], v[184:187]
    v_mfma_f32_16x16x32_bf16 v[188:191], v[72:75], v[148:151], v[188:191]
    v_mfma_f32_16x16x32_bf16 v[180:183], v[84:87], v[128:131], v[180:183]
    v_mfma_f32_16x16x32_bf16 v[184:187], v[84:87], v[132:135], v[184:187]
    v_mfma_f32_16x16x32_bf16 v[188:191], v[84:87], v[136:139], v[188:191]
    s_waitcnt lgkmcnt(3)
    v_mfma_f32_16x16x32_bf16 v[184:187], v[64:67], v[152:155], v[184:187]
    v_mfma_f32_16x16x32_bf16 v[188:191], v[68:71], v[152:155], v[188:191]
    v_mfma_f32_16x16x32_bf16 v[184:187], v[88:91], v[128:131], v[184:187]
    v_mfma_f32_16x16x32_bf16 v[188:191], v[88:91], v[132:135], v[188:191]
    s_waitcnt lgkmcnt(0)
    v_mfma_f32_16x16x32_bf16 v[188:191], v[64:67], v[156:159], v[188:191]
    v_mfma_f32_16x16x32_bf16 v[188:191], v[92:95], v[128:131], v[188:191]
    s_setprio 3
    ds_read_b64 v[192:193], v24 offset:0
    ds_read_b64 v[194:195], v24 offset:512
    ds_read_b64 v[196:197], v24 offset:1024
    ds_read_b64 v[198:199], v24 offset:1536
    s_mov_b32 s10, 0
Lcv_fr:
    ds_read_b32 v2, v28 offset:6400
    s_waitcnt lgkmcnt(0)
    v_cmp_gt_u32 vcc, 8, v2
    s_cbranch_vccz Lcv_fr_ok
    s_add_u32 s10, s10, 1
    s_cmp_lt_u32 s10, 300000
    s_cbranch_scc1 Lcv_fr
Lcv_fr_ok:
    s_cmp_eq_u32 s55, 0
    s_cbranch_scc1 Lcv_noswap
    v_swap_b32 v160, v176
    v_swap_b32 v161, v177
    v_swap_b32 v162, v178
    v_swap_b32 v163, v179
    v_swap_b32 v164, v180
    v_swap_b32 v165, v181
    v_swap_b32 v166, v182
    v_swap_b32 v167, v183
    v_swap_b32 v168, v184
    v_swap_b32 v169, v185
    v_swap_b32 v170, v186
    v_swap_b32 v171, v187
    v_swap_b32 v172, v188
    v_swap_b32 v173, v189
    v_swap_b32 v174, v190
    v_swap_b32 v175, v191
Lcv_noswap:
    ds_write_b128 v23, v[176:179] offset:0
    ds_write_b128 v23, v[180:183] offset:1024
    ds_write_b128 v23, v[184:187] offset:2048
    ds_write_b128 v23, v[188:191] offset:3072
    s_mov_b64 exec, 1
    ds_write_b32 v25, v18 offset:6448
    s_mov_b64 exec, -1
    v_xor_b32 v1, 4, v25
    s_waitcnt lgkmcnt(5)
    v_lshlrev_b32 v216, 16, v192
    v_and_b32 v217, 0xffff0000, v192
    v_lshlrev_b32 v218, 16, v193
    v_and_b32 v219, 0xffff0000, v193
    v_mul_f32 v216, s58, v216
    v_mul_f32 v217, s59, v217
    v_mul_f32 v218, s58, v218
    v_mul_f32 v219, s59, v219
    v_cvt_pk_bf16_f32 v216, 0, v216
    v_cvt_pk_bf16_f32 v217, 0, v217
    v_cvt_pk_bf16_f32 v218, 0, v218
    v_cvt_pk_bf16_f32 v219, 0, v219
    v_lshlrev_b32 v220, 16, v194
    v_and_b32 v221, 0xffff0000, v194
    v_lshlrev_b32 v222, 16, v195
    v_and_b32 v223, 0xffff0000, v195
    v_mul_f32 v220, s58, v220
    v_mul_f32 v221, s59, v221
    v_mul_f32 v222, s58, v222
    v_mul_f32 v223, s59, v223
    v_cvt_pk_bf16_f32 v220, 0, v220
    v_cvt_pk_bf16_f32 v221, 0, v221
    v_cvt_pk_bf16_f32 v222, 0, v222
    v_cvt_pk_bf16_f32 v223, 0, v223
    v_lshlrev_b32 v224, 16, v196
    v_and_b32 v225, 0xffff0000, v196
    v_lshlrev_b32 v226, 16, v197
    v_and_b32 v227, 0xffff0000, v197
    v_mul_f32 v224, s58, v224
    v_mul_f32 v225, s59, v225
    v_mul_f32 v226, s58, v226
    v_mul_f32 v227, s59, v227
    v_cvt_pk_bf16_f32 v224, 0, v224
    v_cvt_pk_bf16_f32 v225, 0, v225
    v_cvt_pk_bf16_f32 v226, 0, v226
    v_cvt_pk_bf16_f32 v227, 0, v227
    v_lshlrev_b32 v228, 16, v198
    v_and_b32 v229, 0xffff0000, v198
    v_lshlrev_b32 v230, 16, v199
    v_and_b32 v231, 0xffff0000, v199
    v_mul_f32 v228, s58, v228
    v_mul_f32 v229, s59, v229
    v_mul_f32 v230, s58, v230
    v_mul_f32 v231, s59, v231
    v_cvt_pk_bf16_f32 v228, 0, v228
    v_cvt_pk_bf16_f32 v229, 0, v229
    v_cvt_pk_bf16_f32 v230, 0, v230
    v_cvt_pk_bf16_f32 v231, 0, v231
    s_mov_b32 s10, 0
Lcv_w:
    ds_read_b32 v2, v1 offset:6448
    s_waitcnt lgkmcnt(0)
    v_cmp_gt_u32 vcc, 1, v2
    s_cbranch_vccz Lcv_w_ok
    s_add_u32 s10, s10, 1
    s_cmp_lt_u32 s10, 300000
    s_cbranch_scc1 Lcv_w
Lcv_w_ok:
    ds_read_b128 v[200:203], v22 offset:0
    ds_read_b128 v[204:207], v22 offset:1024
    ds_read_b128 v[208:211], v22 offset:2048
    ds_read_b128 v[212:215], v22 offset:3072
    s_lshl_b32 s60, s56, 12
    s_lshl_b32 s3, s55, 11
    s_add_u32 s60, s60, s3
    s_add_u32 s60, s60, 10485760
    v_lshlrev_b32 v3, 3, v0
    s_waitcnt lgkmcnt(3)
    v_add_f32 v160, v200, v160
    v_add_f32 v161, v201, v161
    v_add_f32 v162, v202, v162
    v_add_f32 v163, v203, v163
    v_cvt_pk_bf16_f32 v160, 0, v160
    v_cvt_pk_bf16_f32 v161, 0, v161
    v_cvt_pk_bf16_f32 v162, 0, v162
    v_cvt_pk_bf16_f32 v163, 0, v163
    v_add_f32 v160, v216, v160
    v_add_f32 v161, v217, v161
    v_add_f32 v162, v218, v162
    v_add_f32 v163, v219, v163
    v_cvt_pk_bf16_f32 v192, v160, v161
    v_cvt_pk_bf16_f32 v193, v162, v163
    buffer_store_dwordx2 v[192:193], v3, s[12:15], s60 offen offset:0 sc1
    s_waitcnt lgkmcnt(2)
    v_add_f32 v164, v204, v164
    v_add_f32 v165, v205, v165
    v_add_f32 v166, v206, v166
    v_add_f32 v167, v207, v167
    v_cvt_pk_bf16_f32 v164, 0, v164
    v_cvt_pk_bf16_f32 v165, 0, v165
    v_cvt_pk_bf16_f32 v166, 0, v166
    v_cvt_pk_bf16_f32 v167, 0, v167
    v_add_f32 v164, v220, v164
    v_add_f32 v165, v221, v165
    v_add_f32 v166, v222, v166
    v_add_f32 v167, v223, v167
    v_cvt_pk_bf16_f32 v194, v164, v165
    v_cvt_pk_bf16_f32 v195, v166, v167
    buffer_store_dwordx2 v[194:195], v3, s[12:15], s60 offen offset:512 sc1
    s_waitcnt lgkmcnt(1)
    v_add_f32 v168, v208, v168
    v_add_f32 v169, v209, v169
    v_add_f32 v170, v210, v170
    v_add_f32 v171, v211, v171
    v_cvt_pk_bf16_f32 v168, 0, v168
    v_cvt_pk_bf16_f32 v169, 0, v169
    v_cvt_pk_bf16_f32 v170, 0, v170
    v_cvt_pk_bf16_f32 v171, 0, v171
    v_add_f32 v168, v224, v168
    v_add_f32 v169, v225, v169
    v_add_f32 v170, v226, v170
    v_add_f32 v171, v227, v171
    v_cvt_pk_bf16_f32 v196, v168, v169
    v_cvt_pk_bf16_f32 v197, v170, v171
    buffer_store_dwordx2 v[196:197], v3, s[12:15], s60 offen offset:1024 sc1
    s_waitcnt lgkmcnt(0)
    v_add_f32 v172, v212, v172
    v_add_f32 v173, v213, v173
    v_add_f32 v174, v214, v174
    v_add_f32 v175, v215, v175
    v_cvt_pk_bf16_f32 v172, 0, v172
    v_cvt_pk_bf16_f32 v173, 0, v173
    v_cvt_pk_bf16_f32 v174, 0, v174
    v_cvt_pk_bf16_f32 v175, 0, v175
    v_add_f32 v172, v228, v172
    v_add_f32 v173, v229, v173
    v_add_f32 v174, v230, v174
    v_add_f32 v175, v231, v175
    v_cvt_pk_bf16_f32 v198, v172, v173
    v_cvt_pk_bf16_f32 v199, v174, v175
    buffer_store_dwordx2 v[198:199], v3, s[12:15], s60 offen offset:1536 sc1
    s_waitcnt vmcnt(0)
    buffer_store_dwordx2 v[16:17], v29, s[12:15], s53 offen sc1
Lm_done:
Lend:
    s_endpgm
.p2align 4
.type Ltable,@object
Ltable:
.long 0x0c000c00, 0x00000c00, 0x00800040, 0x010000c0
.long 0x01800140, 0x000401c0, 0x00840044, 0x010400c4
.long 0x01840144, 0x000801c4, 0x00880048, 0x010800c8
.long 0x01880148, 0x000c01c8, 0x008c004c, 0x010c00cc
.long 0x018c014c, 0x001001cc, 0x00900050, 0x011000d0
.long 0x01900150, 0x001401d0, 0x00940054, 0x011400d4
.long 0x01940154, 0x001801d4, 0x00980058, 0x011800d8
.long 0x01980158, 0x001c01d8, 0x009c005c, 0x011c00dc
.long 0x019c015c, 0x002001dc, 0x00a00060, 0x012000e0
.long 0x01a00160, 0x002401e0, 0x00a40064, 0x012400e4
.long 0x01a40164, 0x002801e4, 0x00a80068, 0x012800e8
.long 0x01a80168, 0x002c01e8, 0x00ac006c, 0x012c00ec
.long 0x01ac016c, 0x003001ec, 0x00b00070, 0x013000f0
.long 0x01b00170, 0x003401f0, 0x00b40074, 0x013400f4
.long 0x01b40174, 0x003801f4, 0x00b80078, 0x013800f8
.long 0x01b80178, 0x003c01f8, 0x00bc007c, 0x013c00fc
.long 0x01bc017c, 0x020001fc, 0x02800240, 0x030002c0
.long 0x03800340, 0x020403c0, 0x02840244, 0x030402c4
.long 0x03840344, 0x020803c4, 0x02880248, 0x030802c8
.long 0x03880348, 0x020c03c8, 0x028c024c, 0x030c02cc
.long 0x038c034c, 0x021003cc, 0x02900250, 0x031002d0
.long 0x03900350, 0x021403d0, 0x02940254, 0x031402d4
.long 0x03940354, 0x021803d4, 0x02980258, 0x031802d8
.long 0x03980358, 0x021c03d8, 0x029c025c, 0x031c02dc
.long 0x039c035c, 0x022003dc, 0x02a00260, 0x032002e0
.long 0x03a00360, 0x022403e0, 0x02a40264, 0x032402e4
.long 0x03a40364, 0x022803e4, 0x02a80268, 0x032802e8
.long 0x03a80368, 0x022c03e8, 0x02ac026c, 0x032c02ec
.long 0x03ac036c, 0x023003ec, 0x02b00270, 0x033002f0
.long 0x03b00370, 0x023403f0, 0x02b40274, 0x033402f4
.long 0x03b40374, 0x023803f4, 0x02b80278, 0x033802f8
.long 0x03b80378, 0x023c03f8, 0x02bc027c, 0x033c02fc
.long 0x03bc037c, 0x040003fc, 0x04400400, 0x04800480
.long 0x04c00480, 0x04040404, 0x04440404, 0x04840484
.long 0x04c40484, 0x04080408, 0x04480408, 0x04880488
.long 0x04c80488, 0x040c040c, 0x044c040c, 0x048c048c
.long 0x04cc048c, 0x04100410, 0x04500410, 0x04900490
.long 0x04d00490, 0x04140414, 0x04540414, 0x04940494
.long 0x04d40494, 0x04180418, 0x04580418, 0x04980498
.long 0x04d80498, 0x041c041c, 0x045c041c, 0x049c049c
.long 0x04dc049c, 0x04200420, 0x04600420, 0x04a004a0
.long 0x04e004a0, 0x04240424, 0x04640424, 0x04a404a4
.long 0x04e404a4, 0x04280428, 0x04680428, 0x04a804a8
.long 0x04e804a8, 0x042c042c, 0x046c042c, 0x04ac04ac
.long 0x04ec04ac, 0x04300430, 0x04700430, 0x04b004b0
.long 0x04f004b0, 0x04340434, 0x04740434, 0x04b404b4
.long 0x04f404b4, 0x04380438, 0x04780438, 0x04b804b8
.long 0x04f804b8, 0x043c043c, 0x047c043c, 0x04bc04bc
.long 0x04fc04bc, 0x05000500, 0x05400500, 0x05800580
.long 0x05c00580, 0x05040504, 0x05440504, 0x05840584
.long 0x05c40584, 0x05080508, 0x05480508, 0x05880588
.long 0x05c80588, 0x050c050c, 0x054c050c, 0x058c058c
.long 0x05cc058c, 0x05100510, 0x05500510, 0x05900590
.long 0x05d00590, 0x05140514, 0x05540514, 0x05940594
.long 0x05d40594, 0x05180518, 0x05580518, 0x05980598
.long 0x05d80598, 0x051c051c, 0x055c051c, 0x059c059c
.long 0x05dc059c, 0x05200520, 0x05600520, 0x05a005a0
.long 0x05e005a0, 0x05240524, 0x05640524, 0x05a405a4
.long 0x05e405a4, 0x05280528, 0x05680528, 0x05a805a8
.long 0x05e805a8, 0x052c052c, 0x056c052c, 0x05ac05ac
.long 0x05ec05ac, 0x05300530, 0x05700530, 0x05b005b0
.long 0x05f005b0, 0x05340534, 0x05740534, 0x05b405b4
.long 0x05f405b4, 0x05380538, 0x05780538, 0x05b805b8
.long 0x05f805b8, 0x053c053c, 0x057c053c, 0x05bc05bc
.long 0x01800140, 0x05bc01c0, 0x060005fc, 0x06040640
.long 0x01840144, 0x064001c4, 0x06040604, 0x06080644
.long 0x01880148, 0x064401c8, 0x06080608, 0x060c0648
.long 0x018c014c, 0x064801cc, 0x060c060c, 0x0610064c
.long 0x01900150, 0x064c01d0, 0x06100610, 0x06140650
.long 0x01940154, 0x065001d4, 0x06140614, 0x06180654
.long 0x01980158, 0x065401d8, 0x06180618, 0x061c0658
.long 0x019c015c, 0x065801dc, 0x061c061c, 0x0620065c
.long 0x01a00160, 0x065c01e0, 0x06200620, 0x06240660
.long 0x01a40164, 0x066001e4, 0x06240624, 0x06280664
.long 0x01a80168, 0x066401e8, 0x06280628, 0x062c0668
.long 0x01ac016c, 0x066801ec, 0x062c062c, 0x0630066c
.long 0x01b00170, 0x066c01f0, 0x06300630, 0x06340670
.long 0x01b40174, 0x067001f4, 0x06340634, 0x06380674
.long 0x01b80178, 0x067401f8, 0x06380638, 0x063c0678
.long 0x01bc017c, 0x067801fc, 0x063c063c, 0x0680067c
.long 0x03800340, 0x067c03c0, 0x06800680, 0x068406c0
.long 0x03840344, 0x06c003c4, 0x06840684, 0x068806c4
.long 0x03880348, 0x06c403c8, 0x06880688, 0x068c06c8
.long 0x038c034c, 0x06c803cc, 0x068c068c, 0x069006cc
.long 0x03900350, 0x06cc03d0, 0x06900690, 0x069406d0
.long 0x03940354, 0x06d003d4, 0x06940694, 0x069806d4
.long 0x03980358, 0x06d403d8, 0x06980698, 0x069c06d8
.long 0x039c035c, 0x06d803dc, 0x069c069c, 0x06a006dc
.long 0x03a00360, 0x06dc03e0, 0x06a006a0, 0x06a406e0
.long 0x03a40364, 0x06e003e4, 0x06a406a4, 0x06a806e4
.long 0x03a80368, 0x06e403e8, 0x06a806a8, 0x06ac06e8
.long 0x03ac036c, 0x06e803ec, 0x06ac06ac, 0x06b006ec
.long 0x03b00370, 0x06ec03f0, 0x06b006b0, 0x06b406f0
.long 0x03b40374, 0x06f003f4, 0x06b406b4, 0x06b806f4
.long 0x03b80378, 0x06f403f8, 0x06b806b8, 0x06bc06f8
.long 0x03bc037c, 0x06f803fc, 0x06bc06bc, 0x070006fc
.long 0x04c00480, 0x06fc0404, 0x07000700, 0x07040740
.long 0x04c40484, 0x07400408, 0x07040704, 0x07080744
.long 0x04c80488, 0x0744040c, 0x07080708, 0x070c0748
.long 0x04cc048c, 0x07480410, 0x070c070c, 0x0710074c
.long 0x04d00490, 0x074c0414, 0x07100710, 0x07140750
.long 0x04d40494, 0x07500418, 0x07140714, 0x07180754
.long 0x04d80498, 0x0754041c, 0x07180718, 0x071c0758
.long 0x04dc049c, 0x07580420, 0x071c071c, 0x0720075c
.long 0x04e004a0, 0x075c0424, 0x07200720, 0x07240760
.long 0x04e404a4, 0x07600428, 0x07240724, 0x07280764
.long 0x04e804a8, 0x0764042c, 0x07280728, 0x072c0768
.long 0x04ec04ac, 0x07680430, 0x072c072c, 0x0730076c
.long 0x04f004b0, 0x076c0434, 0x07300730, 0x07340770
.long 0x04f404b4, 0x07700438, 0x07340734, 0x07380774
.long 0x04f804b8, 0x0774043c, 0x07380738, 0x073c0778
.long 0x04fc04bc, 0x07780500, 0x073c073c, 0x0780077c
.long 0x05c00580, 0x077c0504, 0x07800780, 0x078407c0
.long 0x05c40584, 0x07c00508, 0x07840784, 0x078807c4
.long 0x05c80588, 0x07c4050c, 0x07880788, 0x078c07c8
.long 0x05cc058c, 0x07c80510, 0x078c078c, 0x079007cc
.long 0x05d00590, 0x07cc0514, 0x07900790, 0x079407d0
.long 0x05d40594, 0x07d00518, 0x07940794, 0x079807d4
.long 0x05d80598, 0x07d4051c, 0x07980798, 0x079c07d8
.long 0x05dc059c, 0x07d80520, 0x079c079c, 0x07a007dc
.long 0x05e005a0, 0x07dc0524, 0x07a007a0, 0x07a407e0
.long 0x05e405a4, 0x07e00528, 0x07a407a4, 0x07a807e4
.long 0x05e805a8, 0x07e4052c, 0x07a807a8, 0x07ac07e8
.long 0x05ec05ac, 0x07e80530, 0x07ac07ac, 0x07b007ec
.long 0x05f005b0, 0x07ec0534, 0x07b007b0, 0x07b407f0
.long 0x05f405b4, 0x07f00538, 0x07b407b4, 0x07b807f4
.long 0x05f805b8, 0x07f4053c, 0x07b807b8, 0x07bc07f8
.long 0x05fc05bc, 0x07f80600, 0x07bc07bc, 0x080007fc
.long 0x080007fc, 0x08040800, 0x09000900, 0x09040900
.long 0x08040804, 0x08080808, 0x09040904, 0x09080908
.long 0x08080808, 0x080c0808, 0x09080908, 0x090c0908
.long 0x080c080c, 0x08100810, 0x090c090c, 0x09100910
.long 0x08100810, 0x08140810, 0x09100910, 0x09140910
.long 0x08140814, 0x08180818, 0x09140914, 0x09180918
.long 0x08180818, 0x081c0818, 0x09180918, 0x091c0918
.long 0x081c081c, 0x08200820, 0x091c091c, 0x09200920
.long 0x08200820, 0x08240820, 0x09200920, 0x09240920
.long 0x08240824, 0x08280828, 0x09240924, 0x09280928
.long 0x08280828, 0x082c0828, 0x09280928, 0x092c0928
.long 0x082c082c, 0x08300830, 0x092c092c, 0x09300930
.long 0x08300830, 0x08340830, 0x09300930, 0x09340930
.long 0x08340834, 0x08380838, 0x09340934, 0x09380938
.long 0x08380838, 0x083c0838, 0x09380938, 0x093c0938
.long 0x083c083c, 0x08400840, 0x093c093c, 0x09400940
.long 0x08400840, 0x08440840, 0x09400940, 0x09440940
.long 0x08440844, 0x08480848, 0x09440944, 0x09480948
.long 0x08480848, 0x084c0848, 0x09480948, 0x094c0948
.long 0x084c084c, 0x08500850, 0x094c094c, 0x09500950
.long 0x08500850, 0x08540850, 0x09500950, 0x09540950
.long 0x08540854, 0x08580858, 0x09540954, 0x09580958
.long 0x08580858, 0x085c0858, 0x09580958, 0x095c0958
.long 0x085c085c, 0x08600860, 0x095c095c, 0x09600960
.long 0x08600860, 0x08640860, 0x09600960, 0x09640960
.long 0x08640864, 0x08680868, 0x09640964, 0x09680968
.long 0x08680868, 0x086c0868, 0x09680968, 0x096c0968
.long 0x086c086c, 0x08700870, 0x096c096c, 0x09700970
.long 0x08700870, 0x08740870, 0x09700970, 0x09740970
.long 0x08740874, 0x08780878, 0x09740974, 0x09780978
.long 0x08780878, 0x087c0878, 0x09780978, 0x097c0978
.long 0x087c087c, 0x08800880, 0x097c097c, 0x09800980
.long 0x08800880, 0x08840880, 0x09800980, 0x09840980
.long 0x08840884, 0x08880888, 0x09840984, 0x09880988
.long 0x08880888, 0x088c0888, 0x09880988, 0x098c0988
.long 0x088c088c, 0x08900890, 0x098c098c, 0x09900990
.long 0x08900890, 0x08940890, 0x09900990, 0x09940990
.long 0x08940894, 0x08980898, 0x09940994, 0x09980998
.long 0x08980898, 0x089c0898, 0x09980998, 0x099c0998
.long 0x089c089c, 0x08a008a0, 0x099c099c, 0x09a009a0
.long 0x08a008a0, 0x08a408a0, 0x09a009a0, 0x09a409a0
.long 0x08a408a4, 0x08a808a8, 0x09a409a4, 0x09a809a8
.long 0x08a808a8, 0x08ac08a8, 0x09a809a8, 0x09ac09a8
.long 0x08ac08ac, 0x08b008b0, 0x09ac09ac, 0x09b009b0
.long 0x08b008b0, 0x08b408b0, 0x09b009b0, 0x09b409b0
.long 0x08b408b4, 0x08b808b8, 0x09b409b4, 0x09b809b8
.long 0x08b808b8, 0x08bc08b8, 0x09b809b8, 0x09bc09b8
.long 0x08bc08bc, 0x08c008c0, 0x09bc09bc, 0x09c009c0
.long 0x08c008c0, 0x08c408c0, 0x09c009c0, 0x09c409c0
.long 0x08c408c4, 0x08c808c8, 0x09c409c4, 0x09c809c8
.long 0x08c808c8, 0x08cc08c8, 0x09c809c8, 0x09cc09c8
.long 0x08cc08cc, 0x08d008d0, 0x09cc09cc, 0x09d009d0
.long 0x08d008d0, 0x08d408d0, 0x09d009d0, 0x09d409d0
.long 0x08d408d4, 0x08d808d8, 0x09d409d4, 0x09d809d8
.long 0x08d808d8, 0x08dc08d8, 0x09d809d8, 0x09dc09d8
.long 0x08dc08dc, 0x08e008e0, 0x09dc09dc, 0x09e009e0
.long 0x08e008e0, 0x08e408e0, 0x09e009e0, 0x09e409e0
.long 0x08e408e4, 0x08e808e8, 0x09e409e4, 0x09e809e8
.long 0x08e808e8, 0x08ec08e8, 0x09e809e8, 0x09ec09e8
.long 0x08ec08ec, 0x08f008f0, 0x09ec09ec, 0x09f009f0
.long 0x08f008f0, 0x08f408f0, 0x09f009f0, 0x09f409f0
.long 0x08f408f4, 0x08f808f8, 0x09f409f4, 0x09f809f8
.long 0x08f808f8, 0x08fc08f8, 0x09f809f8, 0x09fc09f8
.long 0x08fc08fc, 0x09000900, 0x09fc09fc, 0x0a000a00
Ltable_end:
.size Ltable, 3072
.section .rodata,"a"
.p2align 6
.amdhsa_kernel gated_mix__ssm_conv_s4__glu_gated_bilinear__prompt_kernel
  .amdhsa_next_free_vgpr 256
  .amdhsa_next_free_sgpr 102
  .amdhsa_accum_offset 256
  .amdhsa_group_segment_fixed_size 0
  .amdhsa_kernarg_size 136
  .amdhsa_user_sgpr_count 2
  .amdhsa_user_sgpr_kernarg_segment_ptr 1
  .amdhsa_system_sgpr_workgroup_id_x 1
  .amdhsa_float_denorm_mode_32 3
.end_amdhsa_kernel
```
